```python
import torch

def _softmax(x, axis=-1):
    return torch.softmax(x, dim=axis)
def _gelu(x):
    return torch.nn.functional.gelu(x, approximate="tanh")
def _silu(x):
    return torch.nn.functional.silu(x)
def _sigmoid(x):
    return torch.sigmoid(x)
def _layernorm(x, axis=-1, eps=1e-5):
    m = x.mean(dim=axis, keepdim=True)
    v = x.var(dim=axis, keepdim=True, unbiased=False)
    return (x - m) / torch.sqrt(v + eps)
def _scatter_add(tgt, idx, src, axis=0):
    return tgt.clone().index_add_(axis, idx, src)
def _segment_sum(src, seg, n):
    out = torch.zeros((n,) + src.shape[1:], dtype=src.dtype)
    return out.index_add_(0, seg, src)
def _pad(x, pw):
    flat = tuple(v for pair in reversed(pw) for v in pair)
    return torch.nn.functional.pad(x, flat)

kernel_name = 'concat_heads__mha_block__mha_block__prompt'

def setup_inputs():

    _w = (lambda a: (lambda t: t.to(torch.bfloat16) if t.is_floating_point() else t)(torch.as_tensor(a)))
    def _A_setup():
        B, S, D, H = 1, 2048, 576, 32
        return {
            "x": _w((lambda *s: torch.randn(*s, dtype=torch.bfloat16) * 0.2)(B, S, D)),
            "wqkv": _w((lambda *s: torch.randn(*s, dtype=torch.bfloat16) * 0.2)(D, 3 * D)),
            "wo": _w((lambda *s: torch.randn(*s, dtype=torch.bfloat16) * 0.05)(D, D)),
        }
    _A_in = _A_setup()

    def _B_setup():
        B, S, D, H = 1, 2048, 576, 32
        return {
            "x": _w((lambda *s: torch.randn(*s, dtype=torch.bfloat16) * 0.2)(B, S, D)),
            "wqkv": _w((lambda *s: torch.randn(*s, dtype=torch.bfloat16) * 0.2)(D, 3 * D)),
            "wo": _w((lambda *s: torch.randn(*s, dtype=torch.bfloat16) * 0.05)(D, D)),
        }
    _B_in = _B_setup()

    return {
        "A_x": _A_in["x"],
        "A_wqkv": _A_in["wqkv"],
        "A_wo": _A_in["wo"],
        "B_x": _B_in["x"],
        "B_wqkv": _B_in["wqkv"],
        "B_wo": _B_in["wo"],
    }

def reference(A_x, A_wqkv, A_wo, B_x, B_wqkv, B_wo):
    def _A_ref(x, wqkv, wo):
        B, S, D = x.shape
        H = 32
        Dh = D // H
        qkv = (lambda x, *d: x.permute(*d))((x @ wqkv).reshape(B, S, 3, H, Dh), 2, 0, 3, 1, 4)
        q, k, v = qkv[0], qkv[1], qkv[2]
        scores = torch.einsum("bhqd,bhkd->bhqk", q, k) * (Dh ** -0.5)
        p = _softmax(scores, axis=-1)
        o = torch.einsum("bhqk,bhkd->bhqd", p, v)
        return (lambda x, *d: x.permute(*d))(o, 0, 2, 1, 3).reshape(B, S, D) @ wo

    def _B_ref(x, wqkv, wo):
        B, S, D = x.shape
        H = 32
        Dh = D // H
        qkv = (lambda x, *d: x.permute(*d))((x @ wqkv).reshape(B, S, 3, H, Dh), 2, 0, 3, 1, 4)
        q, k, v = qkv[0], qkv[1], qkv[2]
        scores = torch.einsum("bhqd,bhkd->bhqk", q, k) * (Dh ** -0.5)
        p = _softmax(scores, axis=-1)
        o = torch.einsum("bhqk,bhkd->bhqd", p, v)
        return (lambda x, *d: x.permute(*d))(o, 0, 2, 1, 3).reshape(B, S, D) @ wo

    a = _A_ref(A_x, A_wqkv, A_wo)
    b = _B_ref(B_x, B_wqkv, B_wo)
    return torch.concatenate([a, b], axis=-1)
```

```asm
; @launch grid=(256,1,1) block=(768,1,1) lds=148736
.amdgcn_target "amdgcn-amd-amdhsa--gfx950"
.text
.globl concat_heads__mha_block__mha_block__prompt_kernel
.p2align 8
.type concat_heads__mha_block__mha_block__prompt_kernel,@function
concat_heads__mha_block__mha_block__prompt_kernel:
  s_cmp_ge_u32 s2, 256
  s_cbranch_scc1 concat_heads__mha_block__mha_block__prompt_kernel_end
  s_load_dwordx2 s[4:5], s[0:1], 64
  s_load_dwordx4 s[72:75], s[0:1], 0
  s_load_dwordx4 s[76:79], s[0:1], 24
  s_load_dwordx2 s[82:83], s[0:1], 56
  s_load_dwordx2 s[12:13], s[0:1], 16
  s_load_dwordx2 s[6:7], s[0:1], 40
  s_load_dwordx2 s[14:15], s[0:1], 48
  v_and_b32 v1, 63, v0
  v_lshrrev_b32 v2, 6, v0
  s_and_b32 s3, s2, 7
  s_lshr_b32 s30, s2, 3
  v_readfirstlane_b32 s16, v2
  s_lshr_b32 s17, s3, 2
  s_lshr_b32 s18, s30, 1
  s_and_b32 s3, s3, 3
  s_lshl_b32 s3, s3, 1
  s_and_b32 s19, s30, 1
  s_add_u32 s19, s19, s3
  s_waitcnt lgkmcnt(0)
  s_cmp_eq_u32 s17, 0
  s_cselect_b32 s56, s72, s76
  s_cselect_b32 s57, s73, s77
  s_cselect_b32 s60, s74, s78
  s_cselect_b32 s61, s75, s79
  s_cselect_b32 s12, s12, s6
  s_cselect_b32 s13, s13, s7
  s_mov_b32 s58, 2359296
  s_mov_b32 s59, 0x20000
  s_mov_b32 s62, 1990656
  s_mov_b32 s63, 0x20000
  s_cmp_ge_u32 s16, 8
  s_cbranch_scc1 concat_heads__mha_block__mha_block__prompt_kernel_loader
  s_cmp_eq_u32 s16, 0
  s_cbranch_scc0 Lpf_2
  s_lshl_b32 s30, s18, 1
  s_and_b32 s31, s19, 1
  s_add_u32 s30, s30, s31
  v_lshrrev_b32 v5, 4, v1
  v_add_u32 v5, 2, v5
  v_min_u32 v5, 5, v5
  v_and_b32 v2, 15, v1
  s_lshr_b32 s31, s19, 1
  s_lshl_b32 s31, s31, 9
  s_lshl_b32 s32, s30, 4
  s_add_u32 s31, s31, s32
  v_add_u32 v2, s31, v2
  v_mul_u32_u24 v2, 1152, v2
  v_lshl_add_u32 v2, v5, 7, v2
  buffer_load_dword v161, v2, s[56:59], 0 offen
  s_branch Lpfd_1
Lpf_2:
  s_cmp_eq_u32 s16, 1
  s_cbranch_scc0 Lpf_3
  s_lshl_b32 s30, s18, 1
  s_and_b32 s31, s19, 1
  s_add_u32 s30, s30, s31
  v_min_u32 v2, 53, v1
  s_mul_i32 s31, s30, 54
  v_add_u32 v2, s31, v2
  v_mul_u32_u24 v3, 2428, v2
  v_lshrrev_b32 v3, 16, v3
  v_mul_u32_u24 v4, 27, v3
  v_sub_u32 v4, v2, v4
  v_add_u32 v3, 128, v3
  v_mul_u32_u24 v3, 3456, v3
  v_lshl_add_u32 v3, v4, 7, v3
  buffer_load_dword v161, v3, s[60:63], 0 offen
  s_branch Lpfd_1
Lpf_3:
  s_cmp_eq_u32 s16, 2
  s_cbranch_scc0 Lpf_4
  s_lshl_b32 s30, s18, 1
  s_and_b32 s31, s19, 1
  s_add_u32 s30, s30, s31
  v_min_u32 v2, 53, v1
  s_mul_i32 s31, s30, 54
  v_add_u32 v2, s31, v2
  v_mul_u32_u24 v3, 2428, v2
  v_lshrrev_b32 v3, 16, v3
  v_mul_u32_u24 v4, 27, v3
  v_sub_u32 v4, v2, v4
  v_add_u32 v3, 192, v3
  v_mul_u32_u24 v3, 3456, v3
  v_lshl_add_u32 v3, v4, 7, v3
  buffer_load_dword v161, v3, s[60:63], 0 offen
  s_branch Lpfd_1
Lpf_4:
Lpfd_1:
  s_mul_i32 s30, s17, 7077888
  s_add_u32 s8, s4, s30
  s_addc_u32 s9, s5, 0
  s_mov_b32 s10, 7077888
  s_mov_b32 s11, 0x20000
  s_cmp_lg_u32 s16, 0
  s_cbranch_scc1 Lnonce_5
  s_memrealtime s[94:95]
  s_waitcnt lgkmcnt(0)
  s_or_b32 s94, s94, 1
  v_mov_b32 v162, s94
  v_mov_b32 v163, 0
  v_mov_b32 v160, 0
  v_cmp_eq_u32 vcc, 0, v1
  s_and_saveexec_b64 s[36:37], vcc
  global_atomic_cmpswap v160, v160, v[162:163], s[82:83] sc0 sc1
  s_mov_b64 exec, s[36:37]
Lnonce_5:
  v_and_b32 v2, 15, v1
  v_lshrrev_b32 v3, 2, v2
  v_and_b32 v4, 3, v2
  v_lshl_add_u32 v4, v3, 3, v4
  v_lshrrev_b32 v5, 1, v2
  v_and_b32 v5, 1, v5
  v_lshl_or_b32 v5, v3, 1, v5
  v_lshrrev_b32 v6, 4, v1
  v_xor_b32 v5, v5, v6
  s_and_b32 s30, s16, 3
  s_lshl_b32 s30, s30, 13
  v_lshlrev_b32 v4, 7, v4
  v_add_u32 v4, s30, v4
  v_lshl_add_u32 v24, v5, 4, v4
  v_xor_b32 v5, 4, v5
  v_lshl_add_u32 v25, v5, 4, v4
  v_lshrrev_b32 v2, 4, v1
  v_lshrrev_b32 v3, 2, v1
  v_and_b32 v3, 3, v3
  v_lshl_add_u32 v4, v2, 3, v3
  v_lshlrev_b32 v4, 8, v4
  v_add_u32 v4, 32768, v4
  v_and_b32 v2, 1, v2
  v_lshl_or_b32 v2, v2, 2, v3
  v_and_b32 v5, 3, v1
  v_lshlrev_b32 v6, 3, v5
  v_add_u32 v6, v6, v4
  s_lshr_b32 s30, s16, 2
  s_lshl_b32 s30, s30, 2
  s_add_u32 s31, s30, 0
  v_xor_b32 v7, s31, v2
  v_lshl_add_u32 v26, v7, 5, v6
  s_add_u32 s31, s30, 1
  v_xor_b32 v7, s31, v2
  v_lshl_add_u32 v27, v7, 5, v6
  s_add_u32 s31, s30, 2
  v_xor_b32 v7, s31, v2
  v_lshl_add_u32 v28, v7, 5, v6
  s_add_u32 s31, s30, 3
  v_xor_b32 v7, s31, v2
  v_lshl_add_u32 v29, v7, 5, v6
  v_add_u32 v5, 12, v5
  v_lshlrev_b32 v2, 1, v2
  v_xor_b32 v5, v5, v2
  v_lshl_add_u32 v5, v5, 4, v4
  v_add_u32 v5, 8, v5
  s_cmp_ge_u32 s16, 4
  s_cselect_b64 vcc, -1, 0
  s_nop 1
  v_cndmask_b32 v28, v28, v5, vcc
  s_lshr_b32 s35, s16, 2
  s_mul_i32 s35, s35, 20224
  v_lshrrev_b32 v2, 2, v1
  v_and_b32 v2, 3, v2
  v_lshrrev_b32 v3, 5, v1
  v_lshl_add_u32 v3, v3, 3, v2
  v_lshrrev_b32 v4, 1, v3
  v_mul_u32_u24 v4, 1152, v4
  v_and_b32 v3, 1, v3
  v_lshl_add_u32 v4, v3, 9, v4
  v_lshrrev_b32 v5, 4, v1
  v_and_b32 v5, 1, v5
  v_lshlrev_b32 v5, 5, v5
  v_and_b32 v6, 3, v1
  v_lshl_add_u32 v5, v6, 3, v5
  v_add_u32 v4, v4, v5
  v_lshlrev_b32 v3, 6, v3
  v_add_u32 v4, s35, v4
  v_add_u32 v8, v4, v3
  v_sub_u32 v9, v4, v3
  v_lshlrev_b32 v4, 3, v3
  v_add_u32 v4, 9216, v4
  v_add_u32 v4, s35, v4
  v_add_u32 v4, v4, v5
  v_add_u32 v6, v4, v3
  v_sub_u32 v7, v4, v3
  v_add_u32 v5, 40576, v5
  v_cmp_le_u32 vcc, 2, v2
  s_nop 1
  v_cndmask_b32 v10, v6, v5, vcc
  v_cndmask_b32 v11, v7, v5, vcc
  v_lshlrev_b32 v4, 6, v2
  v_add_u32 v5, v5, v4
  v_add_u32 v5, 640, v5
  v_cmp_eq_u32 vcc, 3, v2
  v_cmp_le_u32 s[38:39], 32, v1
  s_or_b64 vcc, vcc, s[38:39]
  s_nop 1
  v_cndmask_b32 v10, v10, v5, vcc
  v_cndmask_b32 v11, v11, v5, vcc
  v_lshrrev_b32 v4, 2, v1
  v_lshrrev_b32 v5, 5, v1
  v_lshlrev_b32 v5, 2, v5
  v_and_b32 v4, 3, v4
  v_or_b32 v4, v4, v5
  v_subrev_u32 v5, 128, v11
  v_cmp_eq_u32 vcc, 3, v4
  s_nop 1
  v_cndmask_b32 v11, v11, v5, vcc
  v_and_b32 v2, 31, v1
  v_lshrrev_b32 v3, 2, v2
  v_and_b32 v3, 1, v3
  v_lshlrev_b32 v3, 3, v3
  v_lshrrev_b32 v4, 3, v2
  v_and_b32 v4, 1, v4
  v_lshl_add_u32 v3, v4, 2, v3
  v_and_b32 v4, 3, v2
  v_add_u32 v3, v3, v4
  v_cmp_gt_u32 vcc, 16, v2
  s_nop 1
  v_cndmask_b32 v3, v2, v3, vcc
  v_lshrrev_b32 v4, 1, v3
  v_mul_u32_u24 v4, 1056, v4
  v_and_b32 v5, 1, v3
  v_lshl_add_u32 v4, v5, 9, v4
  v_lshrrev_b32 v3, 5, v1
  v_xor_b32 v5, v5, v3
  v_lshl_add_u32 v4, v5, 4, v4
  v_add_u32 v4, 10496, v4
  v_add_u32 v12, s35, v4
  v_lshlrev_b32 v3, 4, v3
  v_add_u32 v4, 40480, v3
  v_cmp_le_u32 vcc, 18, v2
  s_nop 1
  v_cndmask_b32 v12, v12, v4, vcc
  v_add_u32 v4, 32, v4
  v_subrev_u32 v5, 20, v2
  v_cmp_gt_u32 vcc, 8, v5
  s_nop 1
  v_cndmask_b32 v12, v12, v4, vcc
  v_cmp_lt_u32 vcc, 18, v2
  v_cmp_ne_u32 s[38:39], 22, v2
  s_and_b64 vcc, vcc, s[38:39]
  v_add_u32 v4, 800, v12
  v_add_u32 v3, 928, v12
  v_subrev_u32 v5, 20, v2
  v_cmp_gt_u32 s[38:39], 8, v5
  s_nop 1
  v_cndmask_b32 v4, v3, v4, s[38:39]
  v_cndmask_b32 v12, v12, v4, vcc
  v_mov_b32 v13, v6
  v_mov_b32 v14, v7
  s_cmp_ge_u32 s16, 4
  s_cbranch_scc1 Lea_6
  s_and_b32 s30, s16, 3
  s_lshl_b32 s30, s30, 7
  v_and_b32 v3, 15, v1
  v_add_u32 v31, 0, v3
  v_cmp_le_u32 vcc, 18, v31
  v_subrev_u32 v32, 18, v31
  s_nop 0
  v_cndmask_b32 v31, v31, v32, vcc
  v_cndmask_b32 v2, 0, 1, vcc
  v_and_b32 v4, 1, v31
  v_lshrrev_b32 v5, 1, v31
  v_lshrrev_b32 v6, 4, v1
  v_mul_u32_u24 v15, 1152, v5
  v_mul_u32_u24 v32, 10496, v2
  v_add3_u32 v15, v15, v32, s30
  v_mul_u32_u24 v32, 576, v4
  v_lshl_add_u32 v32, v6, 4, v32
  v_add_u32 v15, v15, v32
  v_add_u32 v15, 125952, v15
  v_lshlrev_b32 v19, 7, v4
  v_sub_u32 v19, 64, v19
  v_add_u32 v19, v15, v19
  v_and_b32 v3, 15, v1
  v_add_u32 v31, 16, v3
  v_cmp_le_u32 vcc, 18, v31
  v_subrev_u32 v32, 18, v31
  s_nop 0
  v_cndmask_b32 v31, v31, v32, vcc
  v_cndmask_b32 v2, 0, 1, vcc
  v_and_b32 v4, 1, v31
  v_lshrrev_b32 v5, 1, v31
  v_lshrrev_b32 v6, 4, v1
  v_mul_u32_u24 v16, 1152, v5
  v_mul_u32_u24 v32, 10496, v2
  v_add3_u32 v16, v16, v32, s30
  v_mul_u32_u24 v32, 576, v4
  v_lshl_add_u32 v32, v6, 4, v32
  v_add_u32 v16, v16, v32
  v_add_u32 v16, 125952, v16
  v_lshlrev_b32 v20, 7, v4
  v_sub_u32 v20, 64, v20
  v_add_u32 v20, v16, v20
  v_and_b32 v3, 15, v1
  v_add_u32 v31, 0, v3
  v_cmp_le_u32 vcc, 18, v31
  v_subrev_u32 v32, 18, v31
  s_nop 0
  v_cndmask_b32 v31, v31, v32, vcc
  v_cndmask_b32 v2, 0, 1, vcc
  v_and_b32 v4, 1, v31
  v_lshrrev_b32 v5, 1, v31
  v_lshrrev_b32 v6, 4, v1
  v_mul_u32_u24 v17, 1152, v5
  v_mul_u32_u24 v32, 20224, v2
  v_add3_u32 v17, v17, v32, s30
  v_mul_u32_u24 v32, 576, v4
  v_lshl_add_u32 v32, v6, 4, v32
  v_add_u32 v17, v17, v32
  v_lshlrev_b32 v21, 7, v4
  v_sub_u32 v21, 64, v21
  v_add_u32 v21, v17, v21
  v_and_b32 v3, 15, v1
  v_add_u32 v31, 16, v3
  v_cmp_le_u32 vcc, 18, v31
  v_subrev_u32 v32, 18, v31
  s_nop 0
  v_cndmask_b32 v31, v31, v32, vcc
  v_cndmask_b32 v2, 0, 1, vcc
  v_and_b32 v4, 1, v31
  v_lshrrev_b32 v5, 1, v31
  v_lshrrev_b32 v6, 4, v1
  v_mul_u32_u24 v18, 1152, v5
  v_mul_u32_u24 v32, 20224, v2
  v_add3_u32 v18, v18, v32, s30
  v_mul_u32_u24 v32, 576, v4
  v_lshl_add_u32 v32, v6, 4, v32
  v_add_u32 v18, v18, v32
  v_lshlrev_b32 v22, 7, v4
  v_sub_u32 v22, 64, v22
  v_add_u32 v22, v18, v22
  s_branch Lea_7
Lea_6:
  s_and_b32 s30, s16, 3
  s_lshl_b32 s30, s30, 7
  v_and_b32 v3, 15, v1
  v_add_u32 v31, 0, v3
  v_cmp_le_u32 vcc, 18, v31
  v_subrev_u32 v32, 18, v31
  s_nop 0
  v_cndmask_b32 v31, v31, v32, vcc
  v_cndmask_b32 v2, 0, 1, vcc
  v_and_b32 v4, 1, v31
  v_lshrrev_b32 v5, 1, v31
  v_lshrrev_b32 v6, 4, v1
  v_mul_u32_u24 v15, 1056, v5
  v_mul_u32_u24 v32, 20224, v2
  v_add3_u32 v15, v15, v32, s30
  v_xor_b32 v32, v6, v4
  v_lshlrev_b32 v32, 4, v32
  v_lshl_add_u32 v32, v4, 9, v32
  v_add_u32 v15, v15, v32
  v_add_u32 v15, 10496, v15
  v_mov_b32 v19, 64
  v_add_u32 v19, v15, v19
  v_and_b32 v3, 15, v1
  v_add_u32 v31, 16, v3
  v_cmp_le_u32 vcc, 18, v31
  v_subrev_u32 v32, 18, v31
  s_nop 0
  v_cndmask_b32 v31, v31, v32, vcc
  v_cndmask_b32 v2, 0, 1, vcc
  v_and_b32 v4, 1, v31
  v_lshrrev_b32 v5, 1, v31
  v_lshrrev_b32 v6, 4, v1
  v_mul_u32_u24 v16, 1056, v5
  v_mul_u32_u24 v32, 20224, v2
  v_add3_u32 v16, v16, v32, s30
  v_xor_b32 v32, v6, v4
  v_lshlrev_b32 v32, 4, v32
  v_lshl_add_u32 v32, v4, 9, v32
  v_add_u32 v16, v16, v32
  v_add_u32 v16, 10496, v16
  v_mov_b32 v20, 64
  v_add_u32 v20, v16, v20
  v_and_b32 v3, 15, v1
  v_lshrrev_b32 v30, 2, v3
  v_and_b32 v31, 3, v3
  v_add_u32 v31, 32, v31
  v_cmp_le_u32 vcc, 18, v31
  v_subrev_u32 v32, 18, v31
  s_nop 0
  v_cndmask_b32 v31, v31, v32, vcc
  v_cndmask_b32 v2, 0, 1, vcc
  v_and_b32 v4, 1, v31
  v_lshrrev_b32 v5, 1, v31
  v_lshrrev_b32 v6, 4, v1
  v_mul_u32_u24 v17, 1152, v5
  v_mul_u32_u24 v32, 20224, v2
  v_add3_u32 v17, v17, v32, s30
  v_mul_u32_u24 v32, 576, v4
  v_lshl_add_u32 v32, v6, 4, v32
  v_add_u32 v17, v17, v32
  v_lshlrev_b32 v21, 7, v4
  v_sub_u32 v21, 64, v21
  v_mul_i32_i24 v32, -9728, v2
  v_add_u32 v32, 125952, v32
  v_cmp_eq_u32 vcc, 0, v30
  s_nop 1
  v_cndmask_b32 v32, 0, v32, vcc
  v_add_u32 v17, v17, v32
  v_mul_u32_u24 v7, 1056, v5
  v_mul_u32_u24 v32, 20224, v2
  v_add3_u32 v7, v7, v32, s30
  v_xor_b32 v32, v6, v4
  v_lshlrev_b32 v32, 4, v32
  v_lshl_add_u32 v32, v4, 9, v32
  v_add_u32 v7, v7, v32
  v_add_u32 v7, 10496, v7
  v_mov_b32 v33, 64
  v_cmp_eq_u32 vcc, 2, v30
  s_nop 1
  v_cndmask_b32 v17, v17, v7, vcc
  v_cndmask_b32 v21, v21, v33, vcc
  v_mov_b32 v23, 1.0
  v_mov_b32 v32, 0x3eae1a93
  v_cmp_eq_u32 vcc, 0, v30
  s_nop 1
  v_cndmask_b32 v23, v23, v32, vcc
  v_cmp_gt_u32 s[54:55], 3, v30
  v_add_u32 v21, v17, v21
Lea_7:
  s_mov_b32 s69, 0
  v_mov_b32 v96, 0
  v_mov_b32 v97, 0
  v_mov_b32 v98, 0
  v_mov_b32 v99, 0
  v_mov_b32 v100, 0
  v_mov_b32 v101, 0
  v_mov_b32 v102, 0
  v_mov_b32 v103, 0
  v_mov_b32 v104, 0
  v_mov_b32 v105, 0
  v_mov_b32 v106, 0
  v_mov_b32 v107, 0
  v_mov_b32 v108, 0
  v_mov_b32 v109, 0
  v_mov_b32 v110, 0
  v_mov_b32 v111, 0
  v_mov_b32 v112, 0
  v_mov_b32 v113, 0
  v_mov_b32 v114, 0
  v_mov_b32 v115, 0
  v_mov_b32 v116, 0
  v_mov_b32 v117, 0
  v_mov_b32 v118, 0
  v_mov_b32 v119, 0
  v_mov_b32 v120, 0
  v_mov_b32 v121, 0
  v_mov_b32 v122, 0
  v_mov_b32 v123, 0
  v_mov_b32 v124, 0
  v_mov_b32 v125, 0
  v_mov_b32 v126, 0
  v_mov_b32 v127, 0
  v_mov_b32 v128, 0
  v_mov_b32 v129, 0
  v_mov_b32 v130, 0
  v_mov_b32 v131, 0
  v_mov_b32 v132, 0
  v_mov_b32 v133, 0
  v_mov_b32 v134, 0
  v_mov_b32 v135, 0
  v_mov_b32 v136, 0
  v_mov_b32 v137, 0
  v_mov_b32 v138, 0
  v_mov_b32 v139, 0
  v_mov_b32 v140, 0
  v_mov_b32 v141, 0
  v_mov_b32 v142, 0
  v_mov_b32 v143, 0
  v_mov_b32 v144, 0
  v_mov_b32 v145, 0
  v_mov_b32 v146, 0
  v_mov_b32 v147, 0
  v_mov_b32 v148, 0
  v_mov_b32 v149, 0
  v_mov_b32 v150, 0
  v_mov_b32 v151, 0
  v_mov_b32 v152, 0
  v_mov_b32 v153, 0
  v_mov_b32 v154, 0
  v_mov_b32 v155, 0
  v_mov_b32 v156, 0
  v_mov_b32 v157, 0
  v_mov_b32 v158, 0
  v_mov_b32 v159, 0
  s_barrier
  s_cmp_eq_u32 s16, 0
  s_cbranch_scc0 Lpf_9
  s_lshl_b32 s30, s18, 1
  s_and_b32 s31, s19, 1
  s_add_u32 s30, s30, s31
  v_lshrrev_b32 v5, 4, v1
  v_add_u32 v5, 6, v5
  v_min_u32 v5, 8, v5
  v_and_b32 v2, 15, v1
  s_lshr_b32 s31, s19, 1
  s_lshl_b32 s31, s31, 9
  s_lshl_b32 s32, s30, 4
  s_add_u32 s31, s31, s32
  v_add_u32 v2, s31, v2
  v_mul_u32_u24 v2, 1152, v2
  v_lshl_add_u32 v2, v5, 7, v2
  buffer_load_dword v161, v2, s[56:59], 0 offen
  s_branch Lpfd_8
Lpf_9:
  s_cmp_eq_u32 s16, 1
  s_cbranch_scc0 Lpf_10
  s_lshl_b32 s30, s18, 1
  s_and_b32 s31, s19, 1
  s_add_u32 s30, s30, s31
  v_min_u32 v2, 53, v1
  s_mul_i32 s31, s30, 54
  v_add_u32 v2, s31, v2
  v_mul_u32_u24 v3, 2428, v2
  v_lshrrev_b32 v3, 16, v3
  v_mul_u32_u24 v4, 27, v3
  v_sub_u32 v4, v2, v4
  v_add_u32 v3, 256, v3
  v_mul_u32_u24 v3, 3456, v3
  v_lshl_add_u32 v3, v4, 7, v3
  buffer_load_dword v161, v3, s[60:63], 0 offen
  s_branch Lpfd_8
Lpf_10:
  s_cmp_eq_u32 s16, 2
  s_cbranch_scc0 Lpf_11
  s_lshl_b32 s30, s18, 1
  s_and_b32 s31, s19, 1
  s_add_u32 s30, s30, s31
  v_min_u32 v2, 53, v1
  s_mul_i32 s31, s30, 54
  v_add_u32 v2, s31, v2
  v_mul_u32_u24 v3, 2428, v2
  v_lshrrev_b32 v3, 16, v3
  v_mul_u32_u24 v4, 27, v3
  v_sub_u32 v4, v2, v4
  v_add_u32 v3, 320, v3
  v_mul_u32_u24 v3, 3456, v3
  v_lshl_add_u32 v3, v4, 7, v3
  buffer_load_dword v161, v3, s[60:63], 0 offen
  s_branch Lpfd_8
Lpf_11:
  s_cmp_eq_u32 s16, 3
  s_cbranch_scc0 Lpf_12
  s_lshl_b32 s30, s18, 1
  s_and_b32 s31, s19, 1
  s_add_u32 s30, s30, s31
  v_min_u32 v2, 53, v1
  s_mul_i32 s31, s30, 54
  v_add_u32 v2, s31, v2
  v_mul_u32_u24 v3, 2428, v2
  v_lshrrev_b32 v3, 16, v3
  v_mul_u32_u24 v4, 27, v3
  v_sub_u32 v4, v2, v4
  v_add_u32 v3, 384, v3
  v_mul_u32_u24 v3, 3456, v3
  v_lshl_add_u32 v3, v4, 7, v3
  buffer_load_dword v161, v3, s[60:63], 0 offen
  s_branch Lpfd_8
Lpf_12:
  s_cmp_eq_u32 s16, 4
  s_cbranch_scc0 Lpf_13
  s_lshl_b32 s30, s18, 1
  s_and_b32 s31, s19, 1
  s_add_u32 s30, s30, s31
  v_min_u32 v2, 53, v1
  s_mul_i32 s31, s30, 54
  v_add_u32 v2, s31, v2
  v_mul_u32_u24 v3, 2428, v2
  v_lshrrev_b32 v3, 16, v3
  v_mul_u32_u24 v4, 27, v3
  v_sub_u32 v4, v2, v4
  v_add_u32 v3, 448, v3
  v_mul_u32_u24 v3, 3456, v3
  v_lshl_add_u32 v3, v4, 7, v3
  buffer_load_dword v161, v3, s[60:63], 0 offen
  s_branch Lpfd_8
Lpf_13:
  s_cmp_eq_u32 s16, 5
  s_cbranch_scc0 Lpf_14
  s_lshl_b32 s30, s18, 1
  s_and_b32 s31, s19, 1
  s_add_u32 s30, s30, s31
  v_min_u32 v2, 53, v1
  s_mul_i32 s31, s30, 54
  v_add_u32 v2, s31, v2
  v_mul_u32_u24 v3, 2428, v2
  v_lshrrev_b32 v3, 16, v3
  v_mul_u32_u24 v4, 27, v3
  v_sub_u32 v4, v2, v4
  v_add_u32 v3, 512, v3
  v_mul_u32_u24 v3, 3456, v3
  v_lshl_add_u32 v3, v4, 7, v3
  buffer_load_dword v161, v3, s[60:63], 0 offen
  s_branch Lpfd_8
Lpf_14:
Lpfd_8:
  s_cmp_ge_u32 s16, 4
  s_cbranch_scc1 concat_heads__mha_block__mha_block__prompt_kernel_g1
  ds_read_b128 v[30:33], v24 offset:0
  ds_read_b128 v[34:37], v24 offset:512
  ds_read_b128 v[38:41], v24 offset:4096
  ds_read_b128 v[42:45], v24 offset:4608
  ds_read_b64_tr_b16 v[62:63], v26 offset:0
  ds_read_b64_tr_b16 v[64:65], v26 offset:1024
  ds_read_b64_tr_b16 v[66:67], v27 offset:0
  ds_read_b64_tr_b16 v[68:69], v27 offset:1024
  ds_read_b64_tr_b16 v[70:71], v28 offset:0
  ds_read_b64_tr_b16 v[72:73], v28 offset:1024
  ds_read_b64_tr_b16 v[74:75], v29 offset:0
  ds_read_b64_tr_b16 v[76:77], v29 offset:1024
  s_mov_b32 s27, 0
concat_heads__mha_block__mha_block__prompt_kernel_gl0:
  s_waitcnt lgkmcnt(6)
  v_mfma_f32_16x16x32_bf16 v[96:99], v[30:33], v[62:65], v[96:99]
  ds_read_b128 v[46:49], v25 offset:0
  v_mfma_f32_16x16x32_bf16 v[112:115], v[34:37], v[62:65], v[112:115]
  ds_read_b128 v[50:53], v25 offset:512
  v_mfma_f32_16x16x32_bf16 v[128:131], v[38:41], v[62:65], v[128:131]
  ds_read_b128 v[54:57], v25 offset:4096
  v_mfma_f32_16x16x32_bf16 v[144:147], v[42:45], v[62:65], v[144:147]
  ds_read_b128 v[58:61], v25 offset:4608
  s_waitcnt lgkmcnt(8)
  v_mfma_f32_16x16x32_bf16 v[100:103], v[30:33], v[66:69], v[100:103]
  ds_read_b64_tr_b16 v[78:79], v26 offset:8192
  v_mfma_f32_16x16x32_bf16 v[116:119], v[34:37], v[66:69], v[116:119]
  ds_read_b64_tr_b16 v[80:81], v26 offset:9216
  v_mfma_f32_16x16x32_bf16 v[132:135], v[38:41], v[66:69], v[132:135]
  ds_read_b64_tr_b16 v[82:83], v27 offset:8192
  v_mfma_f32_16x16x32_bf16 v[148:151], v[42:45], v[66:69], v[148:151]
  ds_read_b64_tr_b16 v[84:85], v27 offset:9216
  s_waitcnt lgkmcnt(10)
  v_mfma_f32_16x16x32_bf16 v[104:107], v[30:33], v[70:73], v[104:107]
  ds_read_b64_tr_b16 v[86:87], v28 offset:8192
  v_mfma_f32_16x16x32_bf16 v[120:123], v[34:37], v[70:73], v[120:123]
  ds_read_b64_tr_b16 v[88:89], v28 offset:9216
  v_mfma_f32_16x16x32_bf16 v[136:139], v[38:41], v[70:73], v[136:139]
  ds_read_b64_tr_b16 v[90:91], v29 offset:8192
  v_mfma_f32_16x16x32_bf16 v[152:155], v[42:45], v[70:73], v[152:155]
  ds_read_b64_tr_b16 v[92:93], v29 offset:9216
  s_waitcnt lgkmcnt(12)
  v_mfma_f32_16x16x32_bf16 v[108:111], v[30:33], v[74:77], v[108:111]
  v_mfma_f32_16x16x32_bf16 v[124:127], v[34:37], v[74:77], v[124:127]
  v_mfma_f32_16x16x32_bf16 v[140:143], v[38:41], v[74:77], v[140:143]
  v_mfma_f32_16x16x32_bf16 v[156:159], v[42:45], v[74:77], v[156:159]
  s_add_u32 s69, s69, 1
  s_cmp_eq_u32 s69, 3
  s_mov_b32 s68, 49152
  s_cmov_b32 s68, 4294868992
  s_cselect_b32 s69, 0, s69
  s_waitcnt lgkmcnt(0)
  s_barrier
  v_add_u32 v24, s68, v24
  v_add_u32 v26, s68, v26
  v_mfma_f32_16x16x32_bf16 v[96:99], v[46:49], v[78:81], v[96:99]
  v_add_u32 v27, s68, v27
  v_mfma_f32_16x16x32_bf16 v[112:115], v[50:53], v[78:81], v[112:115]
  v_add_u32 v28, s68, v28
  v_mfma_f32_16x16x32_bf16 v[128:131], v[54:57], v[78:81], v[128:131]
  v_add_u32 v29, s68, v29
  v_mfma_f32_16x16x32_bf16 v[144:147], v[58:61], v[78:81], v[144:147]
  v_add_u32 v25, s68, v25
  v_mfma_f32_16x16x32_bf16 v[100:103], v[46:49], v[82:85], v[100:103]
  ds_read_b128 v[30:33], v24 offset:0
  v_mfma_f32_16x16x32_bf16 v[116:119], v[50:53], v[82:85], v[116:119]
  ds_read_b128 v[34:37], v24 offset:512
  v_mfma_f32_16x16x32_bf16 v[132:135], v[54:57], v[82:85], v[132:135]
  ds_read_b128 v[38:41], v24 offset:4096
  v_mfma_f32_16x16x32_bf16 v[148:151], v[58:61], v[82:85], v[148:151]
  ds_read_b128 v[42:45], v24 offset:4608
  v_mfma_f32_16x16x32_bf16 v[104:107], v[46:49], v[86:89], v[104:107]
  ds_read_b64_tr_b16 v[62:63], v26 offset:0
  v_mfma_f32_16x16x32_bf16 v[120:123], v[50:53], v[86:89], v[120:123]
  ds_read_b64_tr_b16 v[64:65], v26 offset:1024
  v_mfma_f32_16x16x32_bf16 v[136:139], v[54:57], v[86:89], v[136:139]
  ds_read_b64_tr_b16 v[66:67], v27 offset:0
  v_mfma_f32_16x16x32_bf16 v[152:155], v[58:61], v[86:89], v[152:155]
  ds_read_b64_tr_b16 v[68:69], v27 offset:1024
  v_mfma_f32_16x16x32_bf16 v[108:111], v[46:49], v[90:93], v[108:111]
  ds_read_b64_tr_b16 v[70:71], v28 offset:0
  v_mfma_f32_16x16x32_bf16 v[124:127], v[50:53], v[90:93], v[124:127]
  ds_read_b64_tr_b16 v[72:73], v28 offset:1024
  v_mfma_f32_16x16x32_bf16 v[140:143], v[54:57], v[90:93], v[140:143]
  ds_read_b64_tr_b16 v[74:75], v29 offset:0
  v_mfma_f32_16x16x32_bf16 v[156:159], v[58:61], v[90:93], v[156:159]
  ds_read_b64_tr_b16 v[76:77], v29 offset:1024
  s_add_u32 s27, s27, 1
  s_cmp_lt_u32 s27, 9
  s_cbranch_scc1 concat_heads__mha_block__mha_block__prompt_kernel_gl0
  s_waitcnt lgkmcnt(0)
  s_nop 7
  s_mov_b32 s33, 0x3eae1a93
  s_lshl_b32 s26, s19, 9
  v_cvt_pk_bf16_f32 v38, v104, v105
  v_cvt_pk_bf16_f32 v39, v106, v107
  v_cvt_pk_bf16_f32 v40, v120, v121
  v_cvt_pk_bf16_f32 v41, v122, v123
  ds_write_b128 v17, v[38:41]
  v_cvt_pk_bf16_f32 v54, v136, v137
  v_cvt_pk_bf16_f32 v55, v138, v139
  v_cvt_pk_bf16_f32 v56, v152, v153
  v_cvt_pk_bf16_f32 v57, v154, v155
  ds_write_b128 v21, v[54:57]
  v_cvt_pk_bf16_f32 v42, v108, v109
  v_cvt_pk_bf16_f32 v43, v110, v111
  v_cvt_pk_bf16_f32 v44, v124, v125
  v_cvt_pk_bf16_f32 v45, v126, v127
  ds_write_b128 v18, v[42:45]
  v_cvt_pk_bf16_f32 v58, v140, v141
  v_cvt_pk_bf16_f32 v59, v142, v143
  v_cvt_pk_bf16_f32 v60, v156, v157
  v_cvt_pk_bf16_f32 v61, v158, v159
  ds_write_b128 v22, v[58:61]
  v_mul_f32 v96, s33, v96
  v_mul_f32 v112, s33, v112
  v_mul_f32 v97, s33, v97
  v_mul_f32 v113, s33, v113
  v_mul_f32 v98, s33, v98
  v_mul_f32 v114, s33, v114
  v_mul_f32 v99, s33, v99
  v_mul_f32 v115, s33, v115
  v_cvt_pk_bf16_f32 v30, v96, v97
  v_cvt_pk_bf16_f32 v31, v98, v99
  v_cvt_pk_bf16_f32 v32, v112, v113
  v_cvt_pk_bf16_f32 v33, v114, v115
  ds_write_b128 v15, v[30:33]
  v_mul_f32 v128, s33, v128
  v_mul_f32 v144, s33, v144
  v_mul_f32 v129, s33, v129
  v_mul_f32 v145, s33, v145
  v_mul_f32 v130, s33, v130
  v_mul_f32 v146, s33, v146
  v_mul_f32 v131, s33, v131
  v_mul_f32 v147, s33, v147
  v_cvt_pk_bf16_f32 v46, v128, v129
  v_cvt_pk_bf16_f32 v47, v130, v131
  v_cvt_pk_bf16_f32 v48, v144, v145
  v_cvt_pk_bf16_f32 v49, v146, v147
  ds_write_b128 v19, v[46:49]
  v_mul_f32 v100, s33, v100
  v_mul_f32 v116, s33, v116
  v_mul_f32 v101, s33, v101
  v_mul_f32 v117, s33, v117
  v_mul_f32 v102, s33, v102
  v_mul_f32 v118, s33, v118
  v_mul_f32 v103, s33, v103
  v_mul_f32 v119, s33, v119
  v_cvt_pk_bf16_f32 v34, v100, v101
  v_cvt_pk_bf16_f32 v35, v102, v103
  v_cvt_pk_bf16_f32 v36, v116, v117
  v_cvt_pk_bf16_f32 v37, v118, v119
  ds_write_b128 v16, v[34:37]
  v_mul_f32 v132, s33, v132
  v_mul_f32 v148, s33, v148
  v_mul_f32 v133, s33, v133
  v_mul_f32 v149, s33, v149
  v_mul_f32 v134, s33, v134
  v_mul_f32 v150, s33, v150
  v_mul_f32 v135, s33, v135
  v_mul_f32 v151, s33, v151
  v_cvt_pk_bf16_f32 v50, v132, v133
  v_cvt_pk_bf16_f32 v51, v134, v135
  v_cvt_pk_bf16_f32 v52, v148, v149
  v_cvt_pk_bf16_f32 v53, v150, v151
  ds_write_b128 v20, v[50:53]
  s_branch concat_heads__mha_block__mha_block__prompt_kernel_gdone
concat_heads__mha_block__mha_block__prompt_kernel_g1:
  s_setprio 1
  ds_read_b128 v[30:33], v24 offset:0
  ds_read_b128 v[34:37], v24 offset:512
  ds_read_b128 v[38:41], v24 offset:4096
  ds_read_b128 v[42:45], v24 offset:4608
  ds_read_b64_tr_b16 v[62:63], v26 offset:0
  ds_read_b64_tr_b16 v[64:65], v26 offset:1024
  ds_read_b64_tr_b16 v[66:67], v27 offset:0
  ds_read_b64_tr_b16 v[68:69], v27 offset:1024
  ds_read_b64_tr_b16 v[70:71], v28 offset:0
  ds_read_b64_tr_b16 v[72:73], v28 offset:1024
  s_mov_b32 s27, 0
concat_heads__mha_block__mha_block__prompt_kernel_gl1:
  s_waitcnt lgkmcnt(4)
  v_mfma_f32_16x16x32_bf16 v[96:99], v[30:33], v[62:65], v[96:99]
  ds_read_b128 v[46:49], v25 offset:0
  v_mfma_f32_16x16x32_bf16 v[112:115], v[34:37], v[62:65], v[112:115]
  ds_read_b128 v[50:53], v25 offset:512
  v_mfma_f32_16x16x32_bf16 v[128:131], v[38:41], v[62:65], v[128:131]
  ds_read_b128 v[54:57], v25 offset:4096
  v_mfma_f32_16x16x32_bf16 v[144:147], v[42:45], v[62:65], v[144:147]
  ds_read_b128 v[58:61], v25 offset:4608
  s_waitcnt lgkmcnt(6)
  v_mfma_f32_16x16x32_bf16 v[100:103], v[30:33], v[66:69], v[100:103]
  ds_read_b64_tr_b16 v[78:79], v26 offset:8192
  v_mfma_f32_16x16x32_bf16 v[116:119], v[34:37], v[66:69], v[116:119]
  ds_read_b64_tr_b16 v[80:81], v26 offset:9216
  v_mfma_f32_16x16x32_bf16 v[132:135], v[38:41], v[66:69], v[132:135]
  ds_read_b64_tr_b16 v[82:83], v27 offset:8192
  v_mfma_f32_16x16x32_bf16 v[148:151], v[42:45], v[66:69], v[148:151]
  ds_read_b64_tr_b16 v[84:85], v27 offset:9216
  s_waitcnt lgkmcnt(8)
  v_mfma_f32_16x16x32_bf16 v[104:107], v[30:33], v[70:73], v[104:107]
  ds_read_b64_tr_b16 v[86:87], v28 offset:8192
  v_mfma_f32_16x16x32_bf16 v[120:123], v[34:37], v[70:73], v[120:123]
  ds_read_b64_tr_b16 v[88:89], v28 offset:9216
  v_mfma_f32_16x16x32_bf16 v[136:139], v[38:41], v[70:73], v[136:139]
  v_mfma_f32_16x16x32_bf16 v[152:155], v[42:45], v[70:73], v[152:155]
  s_add_u32 s69, s69, 1
  s_cmp_eq_u32 s69, 3
  s_mov_b32 s68, 49152
  s_cmov_b32 s68, 4294868992
  s_cselect_b32 s69, 0, s69
  s_waitcnt lgkmcnt(0)
  s_barrier
  v_add_u32 v24, s68, v24
  v_add_u32 v26, s68, v26
  v_mfma_f32_16x16x32_bf16 v[96:99], v[46:49], v[78:81], v[96:99]
  v_add_u32 v27, s68, v27
  v_mfma_f32_16x16x32_bf16 v[112:115], v[50:53], v[78:81], v[112:115]
  v_add_u32 v28, s68, v28
  v_mfma_f32_16x16x32_bf16 v[128:131], v[54:57], v[78:81], v[128:131]
  v_add_u32 v25, s68, v25
  v_mfma_f32_16x16x32_bf16 v[144:147], v[58:61], v[78:81], v[144:147]
  ds_read_b128 v[30:33], v24 offset:0
  v_mfma_f32_16x16x32_bf16 v[100:103], v[46:49], v[82:85], v[100:103]
  ds_read_b128 v[34:37], v24 offset:512
  v_mfma_f32_16x16x32_bf16 v[116:119], v[50:53], v[82:85], v[116:119]
  ds_read_b128 v[38:41], v24 offset:4096
  v_mfma_f32_16x16x32_bf16 v[132:135], v[54:57], v[82:85], v[132:135]
  ds_read_b128 v[42:45], v24 offset:4608
  v_mfma_f32_16x16x32_bf16 v[148:151], v[58:61], v[82:85], v[148:151]
  ds_read_b64_tr_b16 v[62:63], v26 offset:0
  v_mfma_f32_16x16x32_bf16 v[104:107], v[46:49], v[86:89], v[104:107]
  ds_read_b64_tr_b16 v[64:65], v26 offset:1024
  v_mfma_f32_16x16x32_bf16 v[120:123], v[50:53], v[86:89], v[120:123]
  ds_read_b64_tr_b16 v[66:67], v27 offset:0
  v_mfma_f32_16x16x32_bf16 v[136:139], v[54:57], v[86:89], v[136:139]
  ds_read_b64_tr_b16 v[68:69], v27 offset:1024
  v_mfma_f32_16x16x32_bf16 v[152:155], v[58:61], v[86:89], v[152:155]
  ds_read_b64_tr_b16 v[70:71], v28 offset:0
  ds_read_b64_tr_b16 v[72:73], v28 offset:1024
  s_add_u32 s27, s27, 1
  s_cmp_lt_u32 s27, 9
  s_cbranch_scc1 concat_heads__mha_block__mha_block__prompt_kernel_gl1
  s_waitcnt lgkmcnt(0)
  s_setprio 0
  s_nop 7
  s_mov_b32 s33, 0x3eae1a93
  s_lshl_b32 s26, s19, 9
  v_cvt_pk_bf16_f32 v30, v96, v97
  v_cvt_pk_bf16_f32 v31, v98, v99
  v_cvt_pk_bf16_f32 v32, v112, v113
  v_cvt_pk_bf16_f32 v33, v114, v115
  ds_write_b128 v15, v[30:33]
  v_cvt_pk_bf16_f32 v46, v128, v129
  v_cvt_pk_bf16_f32 v47, v130, v131
  v_cvt_pk_bf16_f32 v48, v144, v145
  v_cvt_pk_bf16_f32 v49, v146, v147
  ds_write_b128 v19, v[46:49]
  v_cvt_pk_bf16_f32 v34, v100, v101
  v_cvt_pk_bf16_f32 v35, v102, v103
  v_cvt_pk_bf16_f32 v36, v116, v117
  v_cvt_pk_bf16_f32 v37, v118, v119
  ds_write_b128 v16, v[34:37]
  v_cvt_pk_bf16_f32 v50, v132, v133
  v_cvt_pk_bf16_f32 v51, v134, v135
  v_cvt_pk_bf16_f32 v52, v148, v149
  v_cvt_pk_bf16_f32 v53, v150, v151
  ds_write_b128 v20, v[50:53]
  s_mov_b64 s[36:37], exec
  s_mov_b64 exec, s[54:55]
  v_mul_f32 v104, v23, v104
  v_mul_f32 v120, v23, v120
  v_mul_f32 v105, v23, v105
  v_mul_f32 v121, v23, v121
  v_mul_f32 v106, v23, v106
  v_mul_f32 v122, v23, v122
  v_mul_f32 v107, v23, v107
  v_mul_f32 v123, v23, v123
  v_cvt_pk_bf16_f32 v38, v104, v105
  v_cvt_pk_bf16_f32 v39, v106, v107
  v_cvt_pk_bf16_f32 v40, v120, v121
  v_cvt_pk_bf16_f32 v41, v122, v123
  ds_write_b128 v17, v[38:41]
  v_mul_f32 v136, v23, v136
  v_mul_f32 v152, v23, v152
  v_mul_f32 v137, v23, v137
  v_mul_f32 v153, v23, v153
  v_mul_f32 v138, v23, v138
  v_mul_f32 v154, v23, v154
  v_mul_f32 v139, v23, v139
  v_mul_f32 v155, v23, v155
  v_cvt_pk_bf16_f32 v54, v136, v137
  v_cvt_pk_bf16_f32 v55, v138, v139
  v_cvt_pk_bf16_f32 v56, v152, v153
  v_cvt_pk_bf16_f32 v57, v154, v155
  ds_write_b128 v21, v[54:57]
  s_mov_b64 exec, s[36:37]
concat_heads__mha_block__mha_block__prompt_kernel_gdone:
  s_waitcnt vmcnt(0)
  s_cmp_lg_u32 s16, 0
  s_cbranch_scc1 Lnonce_15
  s_waitcnt vmcnt(0)
  v_cmp_eq_u32 vcc, 0, v160
  v_mov_b32 v2, 148480
  s_nop 0
  v_cndmask_b32 v160, v160, v162, vcc
  v_cmp_eq_u32 vcc, 0, v1
  s_and_saveexec_b64 s[36:37], vcc
  ds_write_b32 v2, v160
  v_mov_b32 v3, 0
  ds_write_b32 v2, v3 offset:4
  ds_write_b32 v2, v3 offset:8
  ds_write_b32 v2, v3 offset:12
  ds_write_b32 v2, v3 offset:16
  s_mov_b64 exec, s[36:37]
Lnonce_15:
  v_mov_b32 v24, 0xdddddddd
  s_waitcnt lgkmcnt(0)
  s_barrier
  s_add_u32 s56, s4, 16777216
  s_addc_u32 s57, s5, 0
  s_mov_b32 s58, 10485760
  s_mov_b32 s59, 0x20000
  s_mov_b32 s60, s12
  s_mov_b32 s61, s13
  s_mov_b32 s62, 663552
  s_mov_b32 s63, 0x20000
  s_mov_b32 s64, s14
  s_mov_b32 s65, s15
  s_mov_b32 s66, 4718592
  s_mov_b32 s67, 0x20000
  s_lshr_b32 s31, s16, 2
  s_mul_i32 s31, s31, 10496
  s_add_u32 s31, s31, 125952
  s_sub_u32 s31, s31, s35
  s_and_b32 s32, s16, 3
  s_lshl_b32 s32, s32, 7
  s_add_u32 s31, s31, s32
  v_add_u32 v2, s31, v8
  v_add_u32 v3, s31, v9
  v_add_u32 v4, s31, v13
  v_add_u32 v5, s31, v14
  ds_read_b64_tr_b16 v[26:27], v2
  ds_read_b64_tr_b16 v[28:29], v2 offset:2304
  ds_read_b64_tr_b16 v[30:31], v3 offset:64
  ds_read_b64_tr_b16 v[32:33], v3 offset:2368
  ds_read_b64_tr_b16 v[34:35], v4
  ds_read_b64_tr_b16 v[36:37], v5 offset:64
  ds_read_b64_tr_b16 v[38:39], v8 offset:0
  ds_read_b64_tr_b16 v[40:41], v8 offset:2304
  ds_read_b64_tr_b16 v[46:47], v10 offset:0
  ds_read_b128 v[50:53], v12 offset:0
  ds_read_b128 v[58:61], v12 offset:32
  v_mov_b32 v132, 0
  v_mov_b32 v133, 0
  v_mov_b32 v134, 0
  v_mov_b32 v135, 0
  v_mov_b32 v136, 0
  v_mov_b32 v137, 0
  v_mov_b32 v138, 0
  v_mov_b32 v139, 0
  v_mov_b32 v140, 0
  v_mov_b32 v141, 0
  v_mov_b32 v142, 0
  v_mov_b32 v143, 0
  v_mov_b32 v144, 0
  v_mov_b32 v145, 0
  v_mov_b32 v146, 0
  v_mov_b32 v147, 0
  v_mov_b32 v148, 0
  v_mov_b32 v149, 0
  v_mov_b32 v150, 0
  v_mov_b32 v151, 0
  v_mov_b32 v152, 0
  v_mov_b32 v153, 0
  v_mov_b32 v154, 0
  v_mov_b32 v155, 0
  v_mov_b32 v156, 0
  v_mov_b32 v157, 0
  v_mov_b32 v158, 0
  v_mov_b32 v159, 0
  v_mov_b32 v160, 0
  v_mov_b32 v161, 0
  v_mov_b32 v162, 0
  v_mov_b32 v163, 0
  v_mov_b32 v124, 0
  v_mov_b32 v125, 0
  v_mov_b32 v126, 0
  v_mov_b32 v127, 0
  v_mov_b32 v128, 0
  v_mov_b32 v129, 0
  v_mov_b32 v130, 0
  v_mov_b32 v131, 0
  v_mov_b32 v62, 0
  v_mov_b32 v63, 0
  v_mov_b32 v64, 0
  v_mov_b32 v65, 0
  s_waitcnt lgkmcnt(0)
  v_mov_b32 v35, 0
  v_mov_b32 v37, 0
  s_mov_b64 s[36:37], exec
  s_mov_b32 exec_lo, 0
  v_mov_b32 v34, 0
  v_mov_b32 v36, 0
  s_mov_b64 exec, s[36:37]
  s_nop 4
  v_mfma_f32_32x32x16_bf16 v[68:83], v[38:41], v[26:29], 0
  v_mfma_f32_32x32x8_bf16 v[68:83], v[46:47], v[34:35], v[68:83]
  v_mfma_f32_32x32x16_bf16 v[84:99], v[38:41], v[30:33], 0
  v_mfma_f32_32x32x8_bf16 v[84:99], v[46:47], v[36:37], v[84:99]
  s_nop 15
  v_max3_f32 v2, v68, v69, v70
  v_max3_f32 v2, v2, v71, v72
  v_max3_f32 v2, v2, v73, v74
  v_max3_f32 v2, v2, v75, v76
  v_max3_f32 v2, v2, v77, v78
  v_max3_f32 v2, v2, v79, v80
  v_max3_f32 v2, v2, v81, v82
  v_max_f32 v2, v2, v83
  v_max3_f32 v3, v84, v85, v86
  v_max3_f32 v3, v3, v87, v88
  v_max3_f32 v3, v3, v89, v90
  v_max3_f32 v3, v3, v91, v92
  v_max3_f32 v3, v3, v93, v94
  v_max3_f32 v3, v3, v95, v96
  v_max3_f32 v3, v3, v97, v98
  v_max_f32 v3, v3, v99
  v_mov_b32 v4, v2
  v_mov_b32 v5, v3
  s_nop 1
  v_permlane32_swap_b32 v2, v4
  v_permlane32_swap_b32 v3, v5
  s_nop 1
  v_max_f32 v2, v2, v4
  v_max_f32 v3, v3, v5
  s_mov_b64 s[36:37], exec
  s_mov_b32 exec_hi, 0
  v_cvt_pk_bf16_f32 v35, -v2, 0
  v_cvt_pk_bf16_f32 v37, -v3, 0
  s_mov_b64 exec, s[36:37]
  s_nop 4
  v_mfma_f32_32x32x16_bf16 v[68:83], v[38:41], v[26:29], 0
  v_mfma_f32_32x32x8_bf16 v[68:83], v[46:47], v[34:35], v[68:83]
  s_nop 15
  s_mov_b32 s27, 0
  s_mov_b32 s29, 0
.p2align 6
concat_heads__mha_block__mha_block__prompt_kernel_loop:
  v_mfma_f32_32x32x16_bf16 v[84:99], v[38:41], v[30:33], 0
  ds_read_b64_tr_b16 v[42:43], v9 offset:64
  ds_read_b64_tr_b16 v[44:45], v9 offset:2368
  ds_read_b64_tr_b16 v[48:49], v11 offset:64
  v_exp_f32 v68, v68
  v_exp_f32 v69, v69
  v_exp_f32 v70, v70
  v_exp_f32 v71, v71
  v_mfma_f32_32x32x8_bf16 v[84:99], v[46:47], v[36:37], v[84:99]
  v_exp_f32 v72, v72
  v_exp_f32 v73, v73
  v_exp_f32 v74, v74
  v_exp_f32 v75, v75
  v_smfmac_f32_32x32x32_bf16 v[148:163], v[62:65], v[124:131], v24
  v_exp_f32 v76, v76
  v_exp_f32 v77, v77
  v_exp_f32 v78, v78
  v_exp_f32 v79, v79
  s_waitcnt lgkmcnt(4)
  v_smfmac_f32_32x32x32_bf16 v[132:147], v[50:53], v[68:75], v24
  v_exp_f32 v80, v80
  v_exp_f32 v81, v81
  v_exp_f32 v82, v82
  v_exp_f32 v83, v83
  s_setprio 2
  s_waitcnt lgkmcnt(0)
  v_mfma_f32_32x32x16_bf16 v[100:115], v[42:45], v[26:29], 0
  ds_read_b128 v[54:57], v12 offset:64
  ds_read_b128 v[62:65], v12 offset:96
  v_exp_f32 v84, v84
  v_exp_f32 v85, v85
  v_exp_f32 v86, v86
  v_exp_f32 v87, v87
  v_mfma_f32_32x32x8_bf16 v[100:115], v[48:49], v[34:35], v[100:115]
  v_exp_f32 v88, v88
  v_exp_f32 v89, v89
  v_exp_f32 v90, v90
  v_exp_f32 v91, v91
  v_smfmac_f32_32x32x32_bf16 v[132:147], v[58:61], v[76:83], v24
  v_exp_f32 v92, v92
  v_exp_f32 v93, v93
  v_exp_f32 v94, v94
  v_exp_f32 v95, v95
  v_smfmac_f32_32x32x32_bf16 v[148:163], v[50:53], v[84:91], v24
  v_exp_f32 v96, v96
  v_exp_f32 v97, v97
  v_exp_f32 v98, v98
  v_exp_f32 v99, v99
  v_mfma_f32_32x32x16_bf16 v[116:131], v[42:45], v[30:33], 0
  ds_read_b64_tr_b16 v[38:39], v8 offset:128
  ds_read_b64_tr_b16 v[40:41], v8 offset:2432
  ds_read_b64_tr_b16 v[46:47], v10 offset:128
  v_exp_f32 v100, v100
  v_exp_f32 v101, v101
  v_exp_f32 v102, v102
  v_exp_f32 v103, v103
  v_mfma_f32_32x32x8_bf16 v[116:131], v[48:49], v[36:37], v[116:131]
  v_exp_f32 v104, v104
  v_exp_f32 v105, v105
  v_exp_f32 v106, v106
  v_exp_f32 v107, v107
  v_smfmac_f32_32x32x32_bf16 v[148:163], v[58:61], v[92:99], v24
  v_exp_f32 v108, v108
  v_exp_f32 v109, v109
  v_exp_f32 v110, v110
  v_exp_f32 v111, v111
  s_waitcnt lgkmcnt(4)
  v_smfmac_f32_32x32x32_bf16 v[132:147], v[54:57], v[100:107], v24
  v_exp_f32 v112, v112
  v_exp_f32 v113, v113
  v_exp_f32 v114, v114
  v_exp_f32 v115, v115
  s_waitcnt lgkmcnt(0)
  v_mfma_f32_32x32x16_bf16 v[68:83], v[38:41], v[26:29], 0
  ds_read_b128 v[50:53], v12 offset:128
  ds_read_b128 v[58:61], v12 offset:160
  v_exp_f32 v116, v116
  v_exp_f32 v117, v117
  v_exp_f32 v118, v118
  v_exp_f32 v119, v119
  v_mfma_f32_32x32x8_bf16 v[68:83], v[46:47], v[34:35], v[68:83]
  v_exp_f32 v120, v120
  v_exp_f32 v121, v121
  v_exp_f32 v122, v122
  v_exp_f32 v123, v123
  v_smfmac_f32_32x32x32_bf16 v[132:147], v[62:65], v[108:115], v24
  v_exp_f32 v124, v124
  v_exp_f32 v125, v125
  v_exp_f32 v126, v126
  v_exp_f32 v127, v127
  v_smfmac_f32_32x32x32_bf16 v[148:163], v[54:57], v[116:123], v24
  v_exp_f32 v128, v128
  v_exp_f32 v129, v129
  v_exp_f32 v130, v130
  v_exp_f32 v131, v131
  v_mfma_f32_32x32x16_bf16 v[84:99], v[38:41], v[30:33], 0
  ds_read_b64_tr_b16 v[42:43], v9 offset:192
  ds_read_b64_tr_b16 v[44:45], v9 offset:2496
  ds_read_b64_tr_b16 v[48:49], v11 offset:192
  v_exp_f32 v68, v68
  v_exp_f32 v69, v69
  v_exp_f32 v70, v70
  v_exp_f32 v71, v71
  v_mfma_f32_32x32x8_bf16 v[84:99], v[46:47], v[36:37], v[84:99]
  v_exp_f32 v72, v72
  v_exp_f32 v73, v73
  v_exp_f32 v74, v74
  v_exp_f32 v75, v75
  v_smfmac_f32_32x32x32_bf16 v[148:163], v[62:65], v[124:131], v24
  v_exp_f32 v76, v76
  v_exp_f32 v77, v77
  v_exp_f32 v78, v78
  v_exp_f32 v79, v79
  s_waitcnt lgkmcnt(4)
  v_smfmac_f32_32x32x32_bf16 v[132:147], v[50:53], v[68:75], v24
  v_exp_f32 v80, v80
  v_exp_f32 v81, v81
  v_exp_f32 v82, v82
  v_exp_f32 v83, v83
  s_setprio 1
  s_waitcnt lgkmcnt(0)
  v_mfma_f32_32x32x16_bf16 v[100:115], v[42:45], v[26:29], 0
  ds_read_b128 v[54:57], v12 offset:192
  ds_read_b128 v[62:65], v12 offset:224
  v_exp_f32 v84, v84
  v_exp_f32 v85, v85
  v_exp_f32 v86, v86
  v_exp_f32 v87, v87
  v_mfma_f32_32x32x8_bf16 v[100:115], v[48:49], v[34:35], v[100:115]
  v_exp_f32 v88, v88
  v_exp_f32 v89, v89
  v_exp_f32 v90, v90
  v_exp_f32 v91, v91
  v_smfmac_f32_32x32x32_bf16 v[132:147], v[58:61], v[76:83], v24
  v_exp_f32 v92, v92
  v_exp_f32 v93, v93
  v_exp_f32 v94, v94
  v_exp_f32 v95, v95
  v_smfmac_f32_32x32x32_bf16 v[148:163], v[50:53], v[84:91], v24
  v_exp_f32 v96, v96
  v_exp_f32 v97, v97
  v_exp_f32 v98, v98
  v_exp_f32 v99, v99
  v_mfma_f32_32x32x16_bf16 v[116:131], v[42:45], v[30:33], 0
  ds_read_b64_tr_b16 v[38:39], v8 offset:256
  ds_read_b64_tr_b16 v[40:41], v8 offset:2560
  ds_read_b64_tr_b16 v[46:47], v10 offset:256
  v_exp_f32 v100, v100
  v_exp_f32 v101, v101
  v_exp_f32 v102, v102
  v_exp_f32 v103, v103
  v_mfma_f32_32x32x8_bf16 v[116:131], v[48:49], v[36:37], v[116:131]
  v_exp_f32 v104, v104
  v_exp_f32 v105, v105
  v_exp_f32 v106, v106
  v_exp_f32 v107, v107
  v_smfmac_f32_32x32x32_bf16 v[148:163], v[58:61], v[92:99], v24
  v_exp_f32 v108, v108
  v_exp_f32 v109, v109
  v_exp_f32 v110, v110
  v_exp_f32 v111, v111
  s_waitcnt lgkmcnt(4)
  v_smfmac_f32_32x32x32_bf16 v[132:147], v[54:57], v[100:107], v24
  v_exp_f32 v112, v112
  v_exp_f32 v113, v113
  v_exp_f32 v114, v114
  v_exp_f32 v115, v115
  s_waitcnt lgkmcnt(0)
  v_mfma_f32_32x32x16_bf16 v[68:83], v[38:41], v[26:29], 0
  ds_read_b128 v[50:53], v12 offset:256
  ds_read_b128 v[58:61], v12 offset:288
  v_exp_f32 v116, v116
  v_exp_f32 v117, v117
  v_exp_f32 v118, v118
  v_exp_f32 v119, v119
  v_mfma_f32_32x32x8_bf16 v[68:83], v[46:47], v[34:35], v[68:83]
  v_exp_f32 v120, v120
  v_exp_f32 v121, v121
  v_exp_f32 v122, v122
  v_exp_f32 v123, v123
  v_smfmac_f32_32x32x32_bf16 v[132:147], v[62:65], v[108:115], v24
  v_exp_f32 v124, v124
  v_exp_f32 v125, v125
  v_exp_f32 v126, v126
  v_exp_f32 v127, v127
  v_smfmac_f32_32x32x32_bf16 v[148:163], v[54:57], v[116:123], v24
  v_exp_f32 v128, v128
  v_exp_f32 v129, v129
  v_exp_f32 v130, v130
  v_exp_f32 v131, v131
  v_mfma_f32_32x32x16_bf16 v[84:99], v[38:41], v[30:33], 0
  ds_read_b64_tr_b16 v[42:43], v9 offset:320
  ds_read_b64_tr_b16 v[44:45], v9 offset:2624
  ds_read_b64_tr_b16 v[48:49], v11 offset:320
  v_exp_f32 v68, v68
  v_exp_f32 v69, v69
  v_exp_f32 v70, v70
  v_exp_f32 v71, v71
  v_mfma_f32_32x32x8_bf16 v[84:99], v[46:47], v[36:37], v[84:99]
  v_exp_f32 v72, v72
  v_exp_f32 v73, v73
  v_exp_f32 v74, v74
  v_exp_f32 v75, v75
  v_smfmac_f32_32x32x32_bf16 v[148:163], v[62:65], v[124:131], v24
  v_exp_f32 v76, v76
  v_exp_f32 v77, v77
  v_exp_f32 v78, v78
  v_exp_f32 v79, v79
  s_waitcnt lgkmcnt(4)
  v_smfmac_f32_32x32x32_bf16 v[132:147], v[50:53], v[68:75], v24
  v_exp_f32 v80, v80
  v_exp_f32 v81, v81
  v_exp_f32 v82, v82
  v_exp_f32 v83, v83
  s_setprio 0
  s_waitcnt lgkmcnt(0)
  v_mfma_f32_32x32x16_bf16 v[100:115], v[42:45], v[26:29], 0
  ds_read_b128 v[54:57], v12 offset:320
  ds_read_b128 v[62:65], v12 offset:352
  v_exp_f32 v84, v84
  v_exp_f32 v85, v85
  v_exp_f32 v86, v86
  v_exp_f32 v87, v87
  v_mfma_f32_32x32x8_bf16 v[100:115], v[48:49], v[34:35], v[100:115]
  v_exp_f32 v88, v88
  v_exp_f32 v89, v89
  v_exp_f32 v90, v90
  v_exp_f32 v91, v91
  v_smfmac_f32_32x32x32_bf16 v[132:147], v[58:61], v[76:83], v24
  v_exp_f32 v92, v92
  v_exp_f32 v93, v93
  v_exp_f32 v94, v94
  v_exp_f32 v95, v95
  v_smfmac_f32_32x32x32_bf16 v[148:163], v[50:53], v[84:91], v24
  v_exp_f32 v96, v96
  v_exp_f32 v97, v97
  v_exp_f32 v98, v98
  v_exp_f32 v99, v99
  v_mfma_f32_32x32x16_bf16 v[116:131], v[42:45], v[30:33], 0
  ds_read_b64_tr_b16 v[38:39], v8 offset:384
  ds_read_b64_tr_b16 v[40:41], v8 offset:2688
  ds_read_b64_tr_b16 v[46:47], v10 offset:384
  v_exp_f32 v100, v100
  v_exp_f32 v101, v101
  v_exp_f32 v102, v102
  v_exp_f32 v103, v103
  v_mfma_f32_32x32x8_bf16 v[116:131], v[48:49], v[36:37], v[116:131]
  v_exp_f32 v104, v104
  v_exp_f32 v105, v105
  v_exp_f32 v106, v106
  v_exp_f32 v107, v107
  v_smfmac_f32_32x32x32_bf16 v[148:163], v[58:61], v[92:99], v24
  v_exp_f32 v108, v108
  v_exp_f32 v109, v109
  v_exp_f32 v110, v110
  v_exp_f32 v111, v111
  s_waitcnt lgkmcnt(4)
  v_smfmac_f32_32x32x32_bf16 v[132:147], v[54:57], v[100:107], v24
  v_exp_f32 v112, v112
  v_exp_f32 v113, v113
  v_exp_f32 v114, v114
  v_exp_f32 v115, v115
  s_waitcnt lgkmcnt(0)
  v_mfma_f32_32x32x16_bf16 v[68:83], v[38:41], v[26:29], 0
  ds_read_b128 v[50:53], v12 offset:384
  ds_read_b128 v[58:61], v12 offset:416
  v_exp_f32 v116, v116
  v_exp_f32 v117, v117
  v_exp_f32 v118, v118
  v_exp_f32 v119, v119
  v_mfma_f32_32x32x8_bf16 v[68:83], v[46:47], v[34:35], v[68:83]
  v_exp_f32 v120, v120
  v_exp_f32 v121, v121
  v_exp_f32 v122, v122
  v_exp_f32 v123, v123
  v_smfmac_f32_32x32x32_bf16 v[132:147], v[62:65], v[108:115], v24
  v_exp_f32 v124, v124
  v_exp_f32 v125, v125
  v_exp_f32 v126, v126
  v_exp_f32 v127, v127
  v_smfmac_f32_32x32x32_bf16 v[148:163], v[54:57], v[116:123], v24
  v_exp_f32 v128, v128
  v_exp_f32 v129, v129
  v_exp_f32 v130, v130
  v_exp_f32 v131, v131
  v_mfma_f32_32x32x16_bf16 v[84:99], v[38:41], v[30:33], 0
  ds_read_b64_tr_b16 v[42:43], v9 offset:448
  ds_read_b64_tr_b16 v[44:45], v9 offset:2752
  ds_read_b64_tr_b16 v[48:49], v11 offset:448
  v_exp_f32 v68, v68
  v_exp_f32 v69, v69
  v_exp_f32 v70, v70
  v_exp_f32 v71, v71
  v_mfma_f32_32x32x8_bf16 v[84:99], v[46:47], v[36:37], v[84:99]
  v_exp_f32 v72, v72
  v_exp_f32 v73, v73
  v_exp_f32 v74, v74
  v_exp_f32 v75, v75
  v_smfmac_f32_32x32x32_bf16 v[148:163], v[62:65], v[124:131], v24
  s_barrier
  s_add_u32 s29, s29, 1
  s_cmp_eq_u32 s29, 3
  s_mov_b32 s28, 41984
  s_cmov_b32 s28, 4294883328
  s_cselect_b32 s29, 0, s29
  v_exp_f32 v76, v76
  v_exp_f32 v77, v77
  v_exp_f32 v78, v78
  v_exp_f32 v79, v79
  s_waitcnt lgkmcnt(4)
  v_smfmac_f32_32x32x32_bf16 v[132:147], v[50:53], v[68:75], v24
  v_exp_f32 v80, v80
  v_exp_f32 v81, v81
  v_exp_f32 v82, v82
  v_exp_f32 v83, v83
  s_setprio 3
  s_waitcnt lgkmcnt(0)
  v_mfma_f32_32x32x16_bf16 v[100:115], v[42:45], v[26:29], 0
  ds_read_b128 v[54:57], v12 offset:448
  ds_read_b128 v[62:65], v12 offset:480
  v_exp_f32 v84, v84
  v_exp_f32 v85, v85
  v_exp_f32 v86, v86
  v_exp_f32 v87, v87
  v_mfma_f32_32x32x8_bf16 v[100:115], v[48:49], v[34:35], v[100:115]
  v_exp_f32 v88, v88
  v_exp_f32 v89, v89
  v_exp_f32 v90, v90
  v_exp_f32 v91, v91
  v_smfmac_f32_32x32x32_bf16 v[132:147], v[58:61], v[76:83], v24
  v_exp_f32 v92, v92
  v_exp_f32 v93, v93
  v_exp_f32 v94, v94
  v_exp_f32 v95, v95
  v_smfmac_f32_32x32x32_bf16 v[148:163], v[50:53], v[84:91], v24
  v_exp_f32 v96, v96
  v_exp_f32 v97, v97
  v_exp_f32 v98, v98
  v_exp_f32 v99, v99
  v_mfma_f32_32x32x16_bf16 v[116:131], v[42:45], v[30:33], 0
  v_add_u32 v8, s28, v8
  v_add_u32 v9, s28, v9
  v_add_u32 v10, s28, v10
  v_add_u32 v11, s28, v11
  ds_read_b64_tr_b16 v[38:39], v8 offset:0
  ds_read_b64_tr_b16 v[40:41], v8 offset:2304
  ds_read_b64_tr_b16 v[46:47], v10 offset:0
  v_exp_f32 v100, v100
  v_exp_f32 v101, v101
  v_exp_f32 v102, v102
  v_exp_f32 v103, v103
  v_mfma_f32_32x32x8_bf16 v[116:131], v[48:49], v[36:37], v[116:131]
  v_exp_f32 v104, v104
  v_exp_f32 v105, v105
  v_exp_f32 v106, v106
  v_exp_f32 v107, v107
  v_smfmac_f32_32x32x32_bf16 v[148:163], v[58:61], v[92:99], v24
  v_exp_f32 v108, v108
  v_exp_f32 v109, v109
  v_exp_f32 v110, v110
  v_exp_f32 v111, v111
  s_waitcnt lgkmcnt(4)
  v_smfmac_f32_32x32x32_bf16 v[132:147], v[54:57], v[100:107], v24
  v_exp_f32 v112, v112
  v_exp_f32 v113, v113
  v_exp_f32 v114, v114
  v_exp_f32 v115, v115
  s_waitcnt lgkmcnt(0)
  v_mfma_f32_32x32x16_bf16 v[68:83], v[38:41], v[26:29], 0
  v_add_u32 v12, s28, v12
  ds_read_b128 v[50:53], v12 offset:0
  ds_read_b128 v[58:61], v12 offset:32
  v_exp_f32 v116, v116
  v_exp_f32 v117, v117
  v_exp_f32 v118, v118
  v_exp_f32 v119, v119
  v_mfma_f32_32x32x8_bf16 v[68:83], v[46:47], v[34:35], v[68:83]
  v_exp_f32 v120, v120
  v_exp_f32 v121, v121
  v_exp_f32 v122, v122
  v_exp_f32 v123, v123
  v_smfmac_f32_32x32x32_bf16 v[132:147], v[62:65], v[108:115], v24
  v_exp_f32 v124, v124
  v_exp_f32 v125, v125
  v_exp_f32 v126, v126
  v_exp_f32 v127, v127
  v_smfmac_f32_32x32x32_bf16 v[148:163], v[54:57], v[116:123], v24
  v_exp_f32 v128, v128
  v_exp_f32 v129, v129
  v_exp_f32 v130, v130
  v_exp_f32 v131, v131
  s_add_u32 s27, s27, 1
  s_cmp_lt_u32 s27, 8
  s_cbranch_scc1 concat_heads__mha_block__mha_block__prompt_kernel_loop
  s_nop 1
  v_smfmac_f32_32x32x32_bf16 v[148:163], v[62:65], v[124:131], v24
  s_nop 15
  v_rcp_f32 v6, v142
  v_rcp_f32 v7, v158
  s_lshl_b32 s30, s17, 3
  s_add_u32 s30, s30, s19
  s_lshl_b32 s30, s30, 4
  s_add_u32 s30, s30, s18
  s_mul_i32 s30, s30, 18432
  s_lshr_b32 s31, s16, 2
  s_and_b32 s32, s16, 3
  s_lshl_b32 s33, s31, 10
  s_add_u32 s33, s33, s30
  s_add_u32 s33, s33, 16384
  s_lshl_b32 s31, s31, 13
  s_add_u32 s30, s30, s31
  s_lshl_b32 s31, s32, 11
  s_add_u32 s30, s30, s31
  s_lshl_b32 s31, s32, 8
  s_add_u32 s33, s33, s31
  v_and_b32 v2, 31, v1
  v_lshrrev_b32 v3, 5, v1
  v_lshlrev_b32 v4, 5, v2
  v_lshl_add_u32 v4, v3, 4, v4
  v_lshlrev_b32 v5, 2, v2
  v_mul_f32 v132, v132, v6
  v_mul_f32 v133, v133, v6
  v_mul_f32 v134, v134, v6
  v_mul_f32 v135, v135, v6
  v_mul_f32 v136, v136, v6
  v_mul_f32 v137, v137, v6
  v_mul_f32 v138, v138, v6
  v_mul_f32 v139, v139, v6
  v_mul_f32 v140, v140, v6
  v_mul_f32 v141, v141, v6
  v_cvt_pk_bf16_f32 v68, v132, v133
  v_cvt_pk_bf16_f32 v69, v134, v135
  v_cvt_pk_bf16_f32 v70, v136, v137
  v_cvt_pk_bf16_f32 v71, v138, v139
  v_cvt_pk_bf16_f32 v72, v140, v141
  buffer_store_dwordx4 v[68:71], v4, s[56:59], s30 offen offset:0 sc1
  s_mov_b64 s[36:37], exec
  s_mov_b32 exec_hi, 0
  buffer_store_dword v72, v5, s[56:59], s33 offen offset:0 sc1
  s_mov_b64 exec, s[36:37]
  v_mul_f32 v148, v148, v7
  v_mul_f32 v149, v149, v7
  v_mul_f32 v150, v150, v7
  v_mul_f32 v151, v151, v7
  v_mul_f32 v152, v152, v7
  v_mul_f32 v153, v153, v7
  v_mul_f32 v154, v154, v7
  v_mul_f32 v155, v155, v7
  v_mul_f32 v156, v156, v7
  v_mul_f32 v157, v157, v7
  v_cvt_pk_bf16_f32 v84, v148, v149
  v_cvt_pk_bf16_f32 v85, v150, v151
  v_cvt_pk_bf16_f32 v86, v152, v153
  v_cvt_pk_bf16_f32 v87, v154, v155
  v_cvt_pk_bf16_f32 v88, v156, v157
  buffer_store_dwordx4 v[84:87], v4, s[56:59], s30 offen offset:1024 sc1
  s_mov_b64 s[36:37], exec
  s_mov_b32 exec_hi, 0
  buffer_store_dword v88, v5, s[56:59], s33 offen offset:128 sc1
  s_mov_b64 exec, s[36:37]
  s_mov_b32 s40, 0x30800000
  s_mov_b32 s41, 0x71800000
  v_mul_f32 v4, 0, v132
  v_fma_f32 v4, v133, 0, v4
  v_fma_f32 v4, v134, 0, v4
  v_fma_f32 v4, v135, 0, v4
  v_fma_f32 v4, v136, 0, v4
  v_fma_f32 v4, v137, 0, v4
  v_fma_f32 v4, v138, 0, v4
  v_fma_f32 v4, v139, 0, v4
  v_fma_f32 v4, v140, 0, v4
  v_fma_f32 v4, v141, 0, v4
  v_mul_f32 v5, 0, v148
  v_fma_f32 v5, v149, 0, v5
  v_fma_f32 v5, v150, 0, v5
  v_fma_f32 v5, v151, 0, v5
  v_fma_f32 v5, v152, 0, v5
  v_fma_f32 v5, v153, 0, v5
  v_fma_f32 v5, v154, 0, v5
  v_fma_f32 v5, v155, 0, v5
  v_fma_f32 v5, v156, 0, v5
  v_fma_f32 v5, v157, 0, v5
  v_add_f32 v4, v4, v5
  v_cmp_gt_f32 vcc, v142, s40
  v_cmp_lt_f32 s[42:43], v142, s41
  s_nop 3
  s_and_b64 s[44:45], vcc, s[42:43]
  v_cmp_gt_f32 vcc, v158, s40
  v_cmp_lt_f32 s[42:43], v158, s41
  s_nop 3
  s_and_b64 s[44:45], s[44:45], vcc
  s_and_b64 s[44:45], s[44:45], s[42:43]
  v_cmp_o_f32 vcc, v4, v4
  s_nop 3
  s_and_b64 s[44:45], s[44:45], vcc
  s_cmp_eq_u64 s[44:45], -1
  s_cbranch_scc1 Lok_16
  v_mov_b32 v2, 148484
  v_mov_b32 v3, 1
  ds_write_b32 v2, v3
  s_waitcnt lgkmcnt(0)
Lok_16:
  s_barrier
  v_mov_b32 v2, 148484
  ds_read_b32 v2, v2
  s_waitcnt lgkmcnt(0)
  v_readfirstlane_b32 s40, v2
  s_nop 3
  s_cmp_lg_u32 s40, 0
  s_cbranch_scc0 concat_heads__mha_block__mha_block__prompt_kernel_go3
  v_subrev_u32 v8, 83968, v8
  v_subrev_u32 v9, 83968, v9
  v_subrev_u32 v10, 83968, v10
  v_subrev_u32 v11, 83968, v11
  v_subrev_u32 v12, 83968, v12
  v_mov_b32 v35, 0
  v_mov_b32 v6, 0xff800000
  v_mov_b32 v132, 0
  v_mov_b32 v133, 0
  v_mov_b32 v134, 0
  v_mov_b32 v135, 0
  v_mov_b32 v136, 0
  v_mov_b32 v137, 0
  v_mov_b32 v138, 0
  v_mov_b32 v139, 0
  v_mov_b32 v140, 0
  v_mov_b32 v141, 0
  v_mov_b32 v142, 0
  v_mov_b32 v143, 0
  v_mov_b32 v144, 0
  v_mov_b32 v145, 0
  v_mov_b32 v146, 0
  v_mov_b32 v147, 0
  v_mov_b32 v37, 0
  v_mov_b32 v7, 0xff800000
  v_mov_b32 v148, 0
  v_mov_b32 v149, 0
  v_mov_b32 v150, 0
  v_mov_b32 v151, 0
  v_mov_b32 v152, 0
  v_mov_b32 v153, 0
  v_mov_b32 v154, 0
  v_mov_b32 v155, 0
  v_mov_b32 v156, 0
  v_mov_b32 v157, 0
  v_mov_b32 v158, 0
  v_mov_b32 v159, 0
  v_mov_b32 v160, 0
  v_mov_b32 v161, 0
  v_mov_b32 v162, 0
  v_mov_b32 v163, 0
  s_mov_b32 s46, 0
concat_heads__mha_block__mha_block__prompt_kernel_sl0:
  s_barrier
  s_mov_b32 s47, 0
concat_heads__mha_block__mha_block__prompt_kernel_st0:
  ds_read_b64_tr_b16 v[38:39], v8 offset:0
  ds_read_b64_tr_b16 v[40:41], v8 offset:2304
  ds_read_b64_tr_b16 v[46:47], v10 offset:0
  s_waitcnt lgkmcnt(0)
  v_mfma_f32_32x32x16_bf16 v[68:83], v[38:41], v[26:29], 0
  v_mfma_f32_32x32x8_bf16 v[68:83], v[46:47], v[34:35], v[68:83]
  v_mfma_f32_32x32x16_bf16 v[84:99], v[38:41], v[30:33], 0
  v_mfma_f32_32x32x8_bf16 v[84:99], v[46:47], v[36:37], v[84:99]
  s_nop 15
  v_max3_f32 v6, v6, v68, v69
  v_max3_f32 v6, v6, v70, v71
  v_max3_f32 v6, v6, v72, v73
  v_max3_f32 v6, v6, v74, v75
  v_max3_f32 v6, v6, v76, v77
  v_max3_f32 v6, v6, v78, v79
  v_max3_f32 v6, v6, v80, v81
  v_max3_f32 v6, v6, v82, v83
  v_max3_f32 v7, v7, v84, v85
  v_max3_f32 v7, v7, v86, v87
  v_max3_f32 v7, v7, v88, v89
  v_max3_f32 v7, v7, v90, v91
  v_max3_f32 v7, v7, v92, v93
  v_max3_f32 v7, v7, v94, v95
  v_max3_f32 v7, v7, v96, v97
  v_max3_f32 v7, v7, v98, v99
  ds_read_b64_tr_b16 v[38:39], v9 offset:64
  ds_read_b64_tr_b16 v[40:41], v9 offset:2368
  ds_read_b64_tr_b16 v[46:47], v11 offset:64
  s_waitcnt lgkmcnt(0)
  v_mfma_f32_32x32x16_bf16 v[68:83], v[38:41], v[26:29], 0
  v_mfma_f32_32x32x8_bf16 v[68:83], v[46:47], v[34:35], v[68:83]
  v_mfma_f32_32x32x16_bf16 v[84:99], v[38:41], v[30:33], 0
  v_mfma_f32_32x32x8_bf16 v[84:99], v[46:47], v[36:37], v[84:99]
  s_nop 15
  v_max3_f32 v6, v6, v68, v69
  v_max3_f32 v6, v6, v70, v71
  v_max3_f32 v6, v6, v72, v73
  v_max3_f32 v6, v6, v74, v75
  v_max3_f32 v6, v6, v76, v77
  v_max3_f32 v6, v6, v78, v79
  v_max3_f32 v6, v6, v80, v81
  v_max3_f32 v6, v6, v82, v83
  v_max3_f32 v7, v7, v84, v85
  v_max3_f32 v7, v7, v86, v87
  v_max3_f32 v7, v7, v88, v89
  v_max3_f32 v7, v7, v90, v91
  v_max3_f32 v7, v7, v92, v93
  v_max3_f32 v7, v7, v94, v95
  v_max3_f32 v7, v7, v96, v97
  v_max3_f32 v7, v7, v98, v99
  v_add_u32 v8, 128, v8
  v_add_u32 v9, 128, v9
  v_add_u32 v10, 128, v10
  v_add_u32 v11, 128, v11
  v_add_u32 v12, 128, v12
  s_add_u32 s47, s47, 1
  s_cmp_lt_u32 s47, 4
  s_cbranch_scc1 concat_heads__mha_block__mha_block__prompt_kernel_st0
  v_subrev_u32 v8, 512, v8
  v_subrev_u32 v9, 512, v9
  v_subrev_u32 v10, 512, v10
  v_subrev_u32 v11, 512, v11
  v_subrev_u32 v12, 512, v12
  s_barrier
  s_add_u32 s46, s46, 1
  s_cmp_lt_u32 s46, 8
  s_cbranch_scc1 concat_heads__mha_block__mha_block__prompt_kernel_sl0
  v_mov_b32 v2, v6
  v_mov_b32 v3, v7
  s_nop 1
  v_permlane32_swap_b32 v6, v2
  v_permlane32_swap_b32 v7, v3
  s_nop 1
  v_max_f32 v6, v6, v2
  v_max_f32 v7, v7, v3
  s_mov_b32 s46, 0
concat_heads__mha_block__mha_block__prompt_kernel_sl1:
  s_barrier
  s_mov_b32 s47, 0
concat_heads__mha_block__mha_block__prompt_kernel_st1:
  ds_read_b64_tr_b16 v[38:39], v8 offset:0
  ds_read_b64_tr_b16 v[40:41], v8 offset:2304
  ds_read_b64_tr_b16 v[46:47], v10 offset:0
  ds_read_b128 v[50:53], v12 offset:0
  ds_read_b128 v[58:61], v12 offset:32
  s_waitcnt lgkmcnt(0)
  v_mfma_f32_32x32x16_bf16 v[68:83], v[38:41], v[26:29], 0
  v_mfma_f32_32x32x8_bf16 v[68:83], v[46:47], v[34:35], v[68:83]
  v_mfma_f32_32x32x16_bf16 v[84:99], v[38:41], v[30:33], 0
  v_mfma_f32_32x32x8_bf16 v[84:99], v[46:47], v[36:37], v[84:99]
  s_nop 15
  v_sub_f32 v68, v68, v6
  v_sub_f32 v69, v69, v6
  v_sub_f32 v70, v70, v6
  v_sub_f32 v71, v71, v6
  v_sub_f32 v72, v72, v6
  v_sub_f32 v73, v73, v6
  v_sub_f32 v74, v74, v6
  v_sub_f32 v75, v75, v6
  v_sub_f32 v76, v76, v6
  v_sub_f32 v77, v77, v6
  v_sub_f32 v78, v78, v6
  v_sub_f32 v79, v79, v6
  v_sub_f32 v80, v80, v6
  v_sub_f32 v81, v81, v6
  v_sub_f32 v82, v82, v6
  v_sub_f32 v83, v83, v6
  v_exp_f32 v68, v68
  v_exp_f32 v69, v69
  v_exp_f32 v70, v70
  v_exp_f32 v71, v71
  v_exp_f32 v72, v72
  v_exp_f32 v73, v73
  v_exp_f32 v74, v74
  v_exp_f32 v75, v75
  v_exp_f32 v76, v76
  v_exp_f32 v77, v77
  v_exp_f32 v78, v78
  v_exp_f32 v79, v79
  v_exp_f32 v80, v80
  v_exp_f32 v81, v81
  v_exp_f32 v82, v82
  v_exp_f32 v83, v83
  s_nop 1
  v_smfmac_f32_32x32x32_bf16 v[132:147], v[50:53], v[68:75], v24
  v_smfmac_f32_32x32x32_bf16 v[132:147], v[58:61], v[76:83], v24
  v_sub_f32 v84, v84, v7
  v_sub_f32 v85, v85, v7
  v_sub_f32 v86, v86, v7
  v_sub_f32 v87, v87, v7
  v_sub_f32 v88, v88, v7
  v_sub_f32 v89, v89, v7
  v_sub_f32 v90, v90, v7
  v_sub_f32 v91, v91, v7
  v_sub_f32 v92, v92, v7
  v_sub_f32 v93, v93, v7
  v_sub_f32 v94, v94, v7
  v_sub_f32 v95, v95, v7
  v_sub_f32 v96, v96, v7
  v_sub_f32 v97, v97, v7
  v_sub_f32 v98, v98, v7
  v_sub_f32 v99, v99, v7
  v_exp_f32 v84, v84
  v_exp_f32 v85, v85
  v_exp_f32 v86, v86
  v_exp_f32 v87, v87
  v_exp_f32 v88, v88
  v_exp_f32 v89, v89
  v_exp_f32 v90, v90
  v_exp_f32 v91, v91
  v_exp_f32 v92, v92
  v_exp_f32 v93, v93
  v_exp_f32 v94, v94
  v_exp_f32 v95, v95
  v_exp_f32 v96, v96
  v_exp_f32 v97, v97
  v_exp_f32 v98, v98
  v_exp_f32 v99, v99
  s_nop 1
  v_smfmac_f32_32x32x32_bf16 v[148:163], v[50:53], v[84:91], v24
  v_smfmac_f32_32x32x32_bf16 v[148:163], v[58:61], v[92:99], v24
  s_nop 7
  ds_read_b64_tr_b16 v[38:39], v9 offset:64
  ds_read_b64_tr_b16 v[40:41], v9 offset:2368
  ds_read_b64_tr_b16 v[46:47], v11 offset:64
  ds_read_b128 v[50:53], v12 offset:64
  ds_read_b128 v[58:61], v12 offset:96
  s_waitcnt lgkmcnt(0)
  v_mfma_f32_32x32x16_bf16 v[68:83], v[38:41], v[26:29], 0
  v_mfma_f32_32x32x8_bf16 v[68:83], v[46:47], v[34:35], v[68:83]
  v_mfma_f32_32x32x16_bf16 v[84:99], v[38:41], v[30:33], 0
  v_mfma_f32_32x32x8_bf16 v[84:99], v[46:47], v[36:37], v[84:99]
  s_nop 15
  v_sub_f32 v68, v68, v6
  v_sub_f32 v69, v69, v6
  v_sub_f32 v70, v70, v6
  v_sub_f32 v71, v71, v6
  v_sub_f32 v72, v72, v6
  v_sub_f32 v73, v73, v6
  v_sub_f32 v74, v74, v6
  v_sub_f32 v75, v75, v6
  v_sub_f32 v76, v76, v6
  v_sub_f32 v77, v77, v6
  v_sub_f32 v78, v78, v6
  v_sub_f32 v79, v79, v6
  v_sub_f32 v80, v80, v6
  v_sub_f32 v81, v81, v6
  v_sub_f32 v82, v82, v6
  v_sub_f32 v83, v83, v6
  v_exp_f32 v68, v68
  v_exp_f32 v69, v69
  v_exp_f32 v70, v70
  v_exp_f32 v71, v71
  v_exp_f32 v72, v72
  v_exp_f32 v73, v73
  v_exp_f32 v74, v74
  v_exp_f32 v75, v75
  v_exp_f32 v76, v76
  v_exp_f32 v77, v77
  v_exp_f32 v78, v78
  v_exp_f32 v79, v79
  v_exp_f32 v80, v80
  v_exp_f32 v81, v81
  v_exp_f32 v82, v82
  v_exp_f32 v83, v83
  s_nop 1
  v_smfmac_f32_32x32x32_bf16 v[132:147], v[50:53], v[68:75], v24
  v_smfmac_f32_32x32x32_bf16 v[132:147], v[58:61], v[76:83], v24
  v_sub_f32 v84, v84, v7
  v_sub_f32 v85, v85, v7
  v_sub_f32 v86, v86, v7
  v_sub_f32 v87, v87, v7
  v_sub_f32 v88, v88, v7
  v_sub_f32 v89, v89, v7
  v_sub_f32 v90, v90, v7
  v_sub_f32 v91, v91, v7
  v_sub_f32 v92, v92, v7
  v_sub_f32 v93, v93, v7
  v_sub_f32 v94, v94, v7
  v_sub_f32 v95, v95, v7
  v_sub_f32 v96, v96, v7
  v_sub_f32 v97, v97, v7
  v_sub_f32 v98, v98, v7
  v_sub_f32 v99, v99, v7
  v_exp_f32 v84, v84
  v_exp_f32 v85, v85
  v_exp_f32 v86, v86
  v_exp_f32 v87, v87
  v_exp_f32 v88, v88
  v_exp_f32 v89, v89
  v_exp_f32 v90, v90
  v_exp_f32 v91, v91
  v_exp_f32 v92, v92
  v_exp_f32 v93, v93
  v_exp_f32 v94, v94
  v_exp_f32 v95, v95
  v_exp_f32 v96, v96
  v_exp_f32 v97, v97
  v_exp_f32 v98, v98
  v_exp_f32 v99, v99
  s_nop 1
  v_smfmac_f32_32x32x32_bf16 v[148:163], v[50:53], v[84:91], v24
  v_smfmac_f32_32x32x32_bf16 v[148:163], v[58:61], v[92:99], v24
  s_nop 7
  v_add_u32 v8, 128, v8
  v_add_u32 v9, 128, v9
  v_add_u32 v10, 128, v10
  v_add_u32 v11, 128, v11
  v_add_u32 v12, 128, v12
  s_add_u32 s47, s47, 1
  s_cmp_lt_u32 s47, 4
  s_cbranch_scc1 concat_heads__mha_block__mha_block__prompt_kernel_st1
  v_subrev_u32 v8, 512, v8
  v_subrev_u32 v9, 512, v9
  v_subrev_u32 v10, 512, v10
  v_subrev_u32 v11, 512, v11
  v_subrev_u32 v12, 512, v12
  s_barrier
  s_add_u32 s46, s46, 1
  s_cmp_lt_u32 s46, 8
  s_cbranch_scc1 concat_heads__mha_block__mha_block__prompt_kernel_sl1
  s_nop 15
  s_waitcnt vmcnt(0)
  v_rcp_f32 v6, v142
  v_rcp_f32 v7, v158
  s_lshl_b32 s30, s17, 3
  s_add_u32 s30, s30, s19
  s_lshl_b32 s30, s30, 4
  s_add_u32 s30, s30, s18
  s_mul_i32 s30, s30, 18432
  s_lshr_b32 s31, s16, 2
  s_and_b32 s32, s16, 3
  s_lshl_b32 s33, s31, 10
  s_add_u32 s33, s33, s30
  s_add_u32 s33, s33, 16384
  s_lshl_b32 s31, s31, 13
  s_add_u32 s30, s30, s31
  s_lshl_b32 s31, s32, 11
  s_add_u32 s30, s30, s31
  s_lshl_b32 s31, s32, 8
  s_add_u32 s33, s33, s31
  v_and_b32 v2, 31, v1
  v_lshrrev_b32 v3, 5, v1
  v_lshlrev_b32 v4, 5, v2
  v_lshl_add_u32 v4, v3, 4, v4
  v_lshlrev_b32 v5, 2, v2
  v_mul_f32 v132, v132, v6
  v_mul_f32 v133, v133, v6
  v_mul_f32 v134, v134, v6
  v_mul_f32 v135, v135, v6
  v_mul_f32 v136, v136, v6
  v_mul_f32 v137, v137, v6
  v_mul_f32 v138, v138, v6
  v_mul_f32 v139, v139, v6
  v_mul_f32 v140, v140, v6
  v_mul_f32 v141, v141, v6
  v_cvt_pk_bf16_f32 v68, v132, v133
  v_cvt_pk_bf16_f32 v69, v134, v135
  v_cvt_pk_bf16_f32 v70, v136, v137
  v_cvt_pk_bf16_f32 v71, v138, v139
  v_cvt_pk_bf16_f32 v72, v140, v141
  buffer_store_dwordx4 v[68:71], v4, s[56:59], s30 offen offset:0 sc1
  s_mov_b64 s[36:37], exec
  s_mov_b32 exec_hi, 0
  buffer_store_dword v72, v5, s[56:59], s33 offen offset:0 sc1
  s_mov_b64 exec, s[36:37]
  v_mul_f32 v148, v148, v7
  v_mul_f32 v149, v149, v7
  v_mul_f32 v150, v150, v7
  v_mul_f32 v151, v151, v7
  v_mul_f32 v152, v152, v7
  v_mul_f32 v153, v153, v7
  v_mul_f32 v154, v154, v7
  v_mul_f32 v155, v155, v7
  v_mul_f32 v156, v156, v7
  v_mul_f32 v157, v157, v7
  v_cvt_pk_bf16_f32 v84, v148, v149
  v_cvt_pk_bf16_f32 v85, v150, v151
  v_cvt_pk_bf16_f32 v86, v152, v153
  v_cvt_pk_bf16_f32 v87, v154, v155
  v_cvt_pk_bf16_f32 v88, v156, v157
  buffer_store_dwordx4 v[84:87], v4, s[56:59], s30 offen offset:1024 sc1
  s_mov_b64 s[36:37], exec
  s_mov_b32 exec_hi, 0
  buffer_store_dword v88, v5, s[56:59], s33 offen offset:128 sc1
  s_mov_b64 exec, s[36:37]
concat_heads__mha_block__mha_block__prompt_kernel_go3:
  s_cmp_lt_u32 s16, 4
  s_cbranch_scc1 Lw4_17
  v_mov_b32 v3, 148480
  v_mov_b32 v4, 1
  s_lshl_b32 s30, s17, 3
  s_add_u32 s30, s30, s19
  s_lshl_b32 s30, s30, 4
  s_add_u32 s30, s30, s18
  s_lshl_b32 s30, s30, 7
  s_add_u32 s30, s30, 9437184
  v_mov_b32 v2, s30
  s_waitcnt vmcnt(0)
  v_cmp_eq_u32 vcc, 0, v1
  s_and_saveexec_b64 s[36:37], vcc
  ds_add_rtn_u32 v4, v3, v4 offset:12
  ds_read_b32 v3, v3
  s_waitcnt lgkmcnt(0)
  v_cmp_eq_u32 vcc, 7, v4
  s_and_b64 exec, exec, vcc
  s_cbranch_execz Lfo_18
  buffer_store_dword v3, v2, s[56:59], 0 offen sc1
Lfo_18:
  s_mov_b64 exec, s[36:37]
  s_branch concat_heads__mha_block__mha_block__prompt_kernel_fin
Lw4_17:
  s_and_b32 s32, s16, 1
  v_and_b32 v2, 15, v1
  v_lshrrev_b32 v3, 1, v2
  v_lshrrev_b32 v4, 4, v1
  v_xor_b32 v3, v3, v4
  s_lshl_b32 s30, s32, 13
  s_add_u32 s30, s30, 18432
  v_lshlrev_b32 v5, 7, v2
  v_add_u32 v5, s30, v5
  v_lshl_add_u32 v24, v3, 4, v5
  v_xor_b32 v3, 4, v3
  v_lshl_add_u32 v25, v3, 4, v5
  v_lshlrev_b32 v4, 11, v4
  v_lshl_add_u32 v4, v2, 2, v4
  s_lshl_b32 s30, s32, 8
  s_add_u32 s30, s30, 18432
  v_add_u32 v29, s30, v4
  v_add_u32 v30, 1024, v29
  v_add_u32 v31, 8192, v29
  v_add_u32 v32, 9216, v29
  v_lshrrev_b32 v2, 4, v1
  v_lshrrev_b32 v3, 2, v1
  v_and_b32 v3, 3, v3
  v_lshl_add_u32 v4, v2, 2, v3
  v_mul_u32_u24 v4, 144, v4
  v_add_u32 v4, 83968, v4
  v_and_b32 v5, 3, v1
  s_cmp_ge_u32 s16, 2
  s_cbranch_scc1 Lt3c_20
  v_lshl_add_u32 v26, v5, 3, v4
  v_lshl_add_u32 v27, v5, 3, v4
  v_add_u32 v27, 32, v27
  v_lshl_add_u32 v28, v5, 3, v4
  v_add_u32 v28, 128, v28
  v_mov_b32 v92, 0
  v_mov_b32 v93, 0
  v_mov_b32 v94, 0
  v_mov_b32 v95, 0
  v_mov_b32 v96, 0
  v_mov_b32 v97, 0
  v_mov_b32 v98, 0
  v_mov_b32 v99, 0
  v_mov_b32 v100, 0
  v_mov_b32 v101, 0
  v_mov_b32 v102, 0
  v_mov_b32 v103, 0
  v_mov_b32 v104, 0
  v_mov_b32 v105, 0
  v_mov_b32 v106, 0
  v_mov_b32 v107, 0
  v_mov_b32 v108, 0
  v_mov_b32 v109, 0
  v_mov_b32 v110, 0
  v_mov_b32 v111, 0
  v_mov_b32 v112, 0
  v_mov_b32 v113, 0
  v_mov_b32 v114, 0
  v_mov_b32 v115, 0
  v_mov_b32 v116, 0
  v_mov_b32 v117, 0
  v_mov_b32 v118, 0
  v_mov_b32 v119, 0
  v_mov_b32 v120, 0
  v_mov_b32 v121, 0
  v_mov_b32 v122, 0
  v_mov_b32 v123, 0
  v_mov_b32 v124, 0
  v_mov_b32 v125, 0
  v_mov_b32 v126, 0
  v_mov_b32 v127, 0
  v_mov_b32 v128, 0
  v_mov_b32 v129, 0
  v_mov_b32 v130, 0
  v_mov_b32 v131, 0
  v_mov_b32 v132, 0
  v_mov_b32 v133, 0
  v_mov_b32 v134, 0
  v_mov_b32 v135, 0
  v_mov_b32 v136, 0
  v_mov_b32 v137, 0
  v_mov_b32 v138, 0
  v_mov_b32 v139, 0
  s_mov_b32 s46, 0
  s_mov_b32 s27, 0
  v_mov_b32 v3, 148480
  v_mov_b32 v4, 1
  s_lshl_b32 s30, s17, 3
  s_add_u32 s30, s30, s19
  s_lshl_b32 s30, s30, 4
  s_add_u32 s30, s30, s18
  s_lshl_b32 s30, s30, 7
  s_add_u32 s30, s30, 9437184
  v_mov_b32 v2, s30
  s_waitcnt vmcnt(0)
  v_cmp_eq_u32 vcc, 0, v1
  s_and_saveexec_b64 s[36:37], vcc
  ds_add_rtn_u32 v4, v3, v4 offset:12
  ds_read_b32 v3, v3
  s_waitcnt lgkmcnt(0)
  v_cmp_eq_u32 vcc, 7, v4
  s_and_b64 exec, exec, vcc
  s_cbranch_execz Lfo_21
  buffer_store_dword v3, v2, s[56:59], 0 offen sc1
Lfo_21:
  s_mov_b64 exec, s[36:37]
  s_barrier
  ds_read_b64_tr_b16 v[66:67], v26 offset:0
  ds_read_b64_tr_b16 v[68:69], v26 offset:2304
  ds_read_b128 v[34:37], v24 offset:0
  ds_read_b128 v[38:41], v24 offset:2048
  ds_read_b128 v[42:45], v24 offset:4096
  ds_read_b128 v[46:49], v24 offset:6144
  ds_read_b64_tr_b16 v[70:71], v27 offset:0
  ds_read_b64_tr_b16 v[72:73], v27 offset:2304
  ds_read_b64_tr_b16 v[74:75], v28 offset:0
  ds_read_b64_tr_b16 v[76:77], v28 offset:2304
concat_heads__mha_block__mha_block__prompt_kernel_t3l0:
  s_waitcnt lgkmcnt(4)
  v_mfma_f32_16x16x32_bf16 v[92:95], v[66:69], v[34:37], v[92:95]
  ds_read_b64_tr_b16 v[78:79], v26 offset:4608
  ds_read_b64_tr_b16 v[80:81], v26 offset:6912
  v_mfma_f32_16x16x32_bf16 v[104:107], v[66:69], v[38:41], v[104:107]
  ds_read_b128 v[50:53], v25 offset:0
  ds_read_b128 v[54:57], v25 offset:2048
  v_mfma_f32_16x16x32_bf16 v[116:119], v[66:69], v[42:45], v[116:119]
  ds_read_b128 v[58:61], v25 offset:4096
  ds_read_b128 v[62:65], v25 offset:6144
  v_mfma_f32_16x16x32_bf16 v[128:131], v[66:69], v[46:49], v[128:131]
  ds_read_b64_tr_b16 v[82:83], v27 offset:4608
  ds_read_b64_tr_b16 v[84:85], v27 offset:6912
  s_waitcnt lgkmcnt(10)
  v_mfma_f32_16x16x32_bf16 v[96:99], v[70:73], v[34:37], v[96:99]
  ds_read_b64_tr_b16 v[86:87], v28 offset:4608
  ds_read_b64_tr_b16 v[88:89], v28 offset:6912
  v_mfma_f32_16x16x32_bf16 v[108:111], v[70:73], v[38:41], v[108:111]
  v_mfma_f32_16x16x32_bf16 v[120:123], v[70:73], v[42:45], v[120:123]
  v_mfma_f32_16x16x32_bf16 v[132:135], v[70:73], v[46:49], v[132:135]
  s_waitcnt lgkmcnt(10)
  v_mfma_f32_16x16x32_bf16 v[100:103], v[74:77], v[34:37], v[100:103]
  v_mfma_f32_16x16x32_bf16 v[112:115], v[74:77], v[38:41], v[112:115]
  v_mfma_f32_16x16x32_bf16 v[124:127], v[74:77], v[42:45], v[124:127]
  v_mfma_f32_16x16x32_bf16 v[136:139], v[74:77], v[46:49], v[136:139]
  s_add_u32 s46, s46, 1
  s_cmp_eq_u32 s46, 4
  s_mov_b32 s47, 16384
  s_cmov_b32 s47, 4294918144
  s_cselect_b32 s46, 0, s46
  s_waitcnt lgkmcnt(0)
  s_barrier
  v_add_u32 v24, s47, v24
  v_add_u32 v25, s47, v25
  s_cmp_eq_u32 s27, 6
  s_mov_b32 s47, 9216
  s_cmov_b32 s47, 4294828032
  v_add_u32 v26, s47, v26
  v_add_u32 v27, s47, v27
  v_add_u32 v28, s47, v28
  s_add_u32 s27, s27, 1
  s_cmp_lt_u32 s27, 8
  s_cbranch_scc0 Lt3p_22
  v_mfma_f32_16x16x32_bf16 v[92:95], v[78:81], v[50:53], v[92:95]
  ds_read_b64_tr_b16 v[66:67], v26 offset:0
  ds_read_b64_tr_b16 v[68:69], v26 offset:2304
  v_mfma_f32_16x16x32_bf16 v[104:107], v[78:81], v[54:57], v[104:107]
  ds_read_b128 v[34:37], v24 offset:0
  ds_read_b128 v[38:41], v24 offset:2048
  v_mfma_f32_16x16x32_bf16 v[116:119], v[78:81], v[58:61], v[116:119]
  ds_read_b128 v[42:45], v24 offset:4096
  ds_read_b128 v[46:49], v24 offset:6144
  v_mfma_f32_16x16x32_bf16 v[128:131], v[78:81], v[62:65], v[128:131]
  ds_read_b64_tr_b16 v[70:71], v27 offset:0
  ds_read_b64_tr_b16 v[72:73], v27 offset:2304
  v_mfma_f32_16x16x32_bf16 v[96:99], v[82:85], v[50:53], v[96:99]
  ds_read_b64_tr_b16 v[74:75], v28 offset:0
  ds_read_b64_tr_b16 v[76:77], v28 offset:2304
  v_mfma_f32_16x16x32_bf16 v[108:111], v[82:85], v[54:57], v[108:111]
  v_mfma_f32_16x16x32_bf16 v[120:123], v[82:85], v[58:61], v[120:123]
  v_mfma_f32_16x16x32_bf16 v[132:135], v[82:85], v[62:65], v[132:135]
  v_mfma_f32_16x16x32_bf16 v[100:103], v[86:89], v[50:53], v[100:103]
  v_mfma_f32_16x16x32_bf16 v[112:115], v[86:89], v[54:57], v[112:115]
  v_mfma_f32_16x16x32_bf16 v[124:127], v[86:89], v[58:61], v[124:127]
  v_mfma_f32_16x16x32_bf16 v[136:139], v[86:89], v[62:65], v[136:139]
  s_branch concat_heads__mha_block__mha_block__prompt_kernel_t3l0
Lt3p_22:
  v_mfma_f32_16x16x32_bf16 v[92:95], v[78:81], v[50:53], v[92:95]
  ds_read_b64_tr_b16 v[66:67], v26 offset:0
  ds_read_b64_tr_b16 v[68:69], v26 offset:2304
  ds_read2_b32 v[34:35], v29 offset0:0 offset1:128
  v_mfma_f32_16x16x32_bf16 v[104:107], v[78:81], v[54:57], v[104:107]
  ds_read2_b32 v[36:37], v30 offset0:0 offset1:128
  ds_read2_b32 v[38:39], v29 offset0:16 offset1:144
  ds_read2_b32 v[40:41], v30 offset0:16 offset1:144
  v_mfma_f32_16x16x32_bf16 v[116:119], v[78:81], v[58:61], v[116:119]
  ds_read2_b32 v[42:43], v29 offset0:32 offset1:160
  ds_read2_b32 v[44:45], v30 offset0:32 offset1:160
  ds_read2_b32 v[46:47], v29 offset0:48 offset1:176
  v_mfma_f32_16x16x32_bf16 v[128:131], v[78:81], v[62:65], v[128:131]
  ds_read2_b32 v[48:49], v30 offset0:48 offset1:176
  ds_read_b64_tr_b16 v[70:71], v27 offset:0
  ds_read_b64_tr_b16 v[72:73], v27 offset:2304
  v_mfma_f32_16x16x32_bf16 v[96:99], v[82:85], v[50:53], v[96:99]
  ds_read_b64_tr_b16 v[74:75], v28 offset:0
  ds_read_b64_tr_b16 v[76:77], v28 offset:2304
  v_mfma_f32_16x16x32_bf16 v[108:111], v[82:85], v[54:57], v[108:111]
  v_mfma_f32_16x16x32_bf16 v[120:123], v[82:85], v[58:61], v[120:123]
  v_mfma_f32_16x16x32_bf16 v[132:135], v[82:85], v[62:65], v[132:135]
  v_mfma_f32_16x16x32_bf16 v[100:103], v[86:89], v[50:53], v[100:103]
  v_mfma_f32_16x16x32_bf16 v[112:115], v[86:89], v[54:57], v[112:115]
  v_mfma_f32_16x16x32_bf16 v[124:127], v[86:89], v[58:61], v[124:127]
  v_mfma_f32_16x16x32_bf16 v[136:139], v[86:89], v[62:65], v[136:139]
  s_waitcnt lgkmcnt(4)
  v_mfma_f32_16x16x32_bf16 v[92:95], v[66:69], v[34:37], v[92:95]
  ds_read_b64_tr_b16 v[78:79], v26 offset:4608
  ds_read_b64_tr_b16 v[80:81], v26 offset:6912
  ds_read2_b32 v[50:51], v31 offset0:0 offset1:128
  v_mfma_f32_16x16x32_bf16 v[104:107], v[66:69], v[38:41], v[104:107]
  ds_read2_b32 v[52:53], v32 offset0:0 offset1:128
  ds_read2_b32 v[54:55], v31 offset0:16 offset1:144
  ds_read2_b32 v[56:57], v32 offset0:16 offset1:144
  v_mfma_f32_16x16x32_bf16 v[116:119], v[66:69], v[42:45], v[116:119]
  ds_read2_b32 v[58:59], v31 offset0:32 offset1:160
  ds_read2_b32 v[60:61], v32 offset0:32 offset1:160
  ds_read2_b32 v[62:63], v31 offset0:48 offset1:176
  v_mfma_f32_16x16x32_bf16 v[128:131], v[66:69], v[46:49], v[128:131]
  ds_read2_b32 v[64:65], v32 offset0:48 offset1:176
  ds_read_b64_tr_b16 v[82:83], v27 offset:4608
  ds_read_b64_tr_b16 v[84:85], v27 offset:6912
  s_waitcnt lgkmcnt(14)
  v_mfma_f32_16x16x32_bf16 v[96:99], v[70:73], v[34:37], v[96:99]
  ds_read_b64_tr_b16 v[86:87], v28 offset:4608
  ds_read_b64_tr_b16 v[88:89], v28 offset:6912
  v_mfma_f32_16x16x32_bf16 v[108:111], v[70:73], v[38:41], v[108:111]
  v_mfma_f32_16x16x32_bf16 v[120:123], v[70:73], v[42:45], v[120:123]
  v_mfma_f32_16x16x32_bf16 v[132:135], v[70:73], v[46:49], v[132:135]
  s_waitcnt lgkmcnt(14)
  v_mfma_f32_16x16x32_bf16 v[100:103], v[74:77], v[34:37], v[100:103]
  v_mfma_f32_16x16x32_bf16 v[112:115], v[74:77], v[38:41], v[112:115]
  v_mfma_f32_16x16x32_bf16 v[124:127], v[74:77], v[42:45], v[124:127]
  v_mfma_f32_16x16x32_bf16 v[136:139], v[74:77], v[46:49], v[136:139]
  s_waitcnt lgkmcnt(0)
  s_barrier
  v_mfma_f32_16x16x32_bf16 v[92:95], v[78:81], v[50:53], v[92:95]
  v_mfma_f32_16x16x32_bf16 v[104:107], v[78:81], v[54:57], v[104:107]
  v_mfma_f32_16x16x32_bf16 v[116:119], v[78:81], v[58:61], v[116:119]
  v_mfma_f32_16x16x32_bf16 v[128:131], v[78:81], v[62:65], v[128:131]
  v_mfma_f32_16x16x32_bf16 v[96:99], v[82:85], v[50:53], v[96:99]
  v_mfma_f32_16x16x32_bf16 v[108:111], v[82:85], v[54:57], v[108:111]
  v_mfma_f32_16x16x32_bf16 v[120:123], v[82:85], v[58:61], v[120:123]
  v_mfma_f32_16x16x32_bf16 v[132:135], v[82:85], v[62:65], v[132:135]
  v_mfma_f32_16x16x32_bf16 v[100:103], v[86:89], v[50:53], v[100:103]
  v_mfma_f32_16x16x32_bf16 v[112:115], v[86:89], v[54:57], v[112:115]
  v_mfma_f32_16x16x32_bf16 v[124:127], v[86:89], v[58:61], v[124:127]
  v_mfma_f32_16x16x32_bf16 v[136:139], v[86:89], v[62:65], v[136:139]
  s_nop 7
  v_and_b32 v2, 15, v1
  s_lshl_b32 s30, s19, 8
  s_lshr_b32 s31, s18, 3
  s_lshl_b32 s31, s31, 7
  s_add_u32 s30, s30, s31
  s_and_b32 s31, s16, 1
  s_lshl_b32 s31, s31, 6
  s_add_u32 s30, s30, s31
  v_add_u32 v2, s30, v2
  v_mul_u32_u24 v2, 2304, v2
  v_lshrrev_b32 v3, 4, v1
  s_mul_i32 s30, s17, 1152
  s_and_b32 s31, s18, 7
  s_mul_i32 s31, s31, 144
  s_add_u32 s30, s30, s31
  v_and_b32 v4, 1, v3
  v_lshlrev_b32 v4, 5, v4
  v_lshrrev_b32 v5, 1, v3
  v_lshl_add_u32 v4, v5, 4, v4
  v_add_u32 v4, v4, v2
  v_lshl_add_u32 v5, v3, 3, v2
  v_cvt_pk_bf16_f32 v34, v92, v93
  v_cvt_pk_bf16_f32 v35, v94, v95
  v_cvt_pk_bf16_f32 v36, v96, v97
  v_cvt_pk_bf16_f32 v37, v98, v99
  v_cvt_pk_bf16_f32 v50, v100, v101
  v_cvt_pk_bf16_f32 v51, v102, v103
  v_cvt_pk_bf16_f32 v38, v104, v105
  v_cvt_pk_bf16_f32 v39, v106, v107
  v_cvt_pk_bf16_f32 v40, v108, v109
  v_cvt_pk_bf16_f32 v41, v110, v111
  v_cvt_pk_bf16_f32 v54, v112, v113
  v_cvt_pk_bf16_f32 v55, v114, v115
  v_cvt_pk_bf16_f32 v42, v116, v117
  v_cvt_pk_bf16_f32 v43, v118, v119
  v_cvt_pk_bf16_f32 v44, v120, v121
  v_cvt_pk_bf16_f32 v45, v122, v123
  v_cvt_pk_bf16_f32 v58, v124, v125
  v_cvt_pk_bf16_f32 v59, v126, v127
  v_cvt_pk_bf16_f32 v46, v128, v129
  v_cvt_pk_bf16_f32 v47, v130, v131
  v_cvt_pk_bf16_f32 v48, v132, v133
  v_cvt_pk_bf16_f32 v49, v134, v135
  v_cvt_pk_bf16_f32 v62, v136, v137
  v_cvt_pk_bf16_f32 v63, v138, v139
  s_nop 1
  v_permlane16_swap_b32 v34, v36
  v_permlane16_swap_b32 v35, v37
  v_permlane16_swap_b32 v38, v40
  v_permlane16_swap_b32 v39, v41
  v_permlane16_swap_b32 v42, v44
  v_permlane16_swap_b32 v43, v45
  v_permlane16_swap_b32 v46, v48
  v_permlane16_swap_b32 v47, v49
  s_nop 1
  buffer_store_dwordx4 v[34:37], v4, s[64:67], s30 offen offset:0
  v_cmp_gt_u32 vcc, 2, v3
  s_and_saveexec_b64 s[36:37], vcc
  buffer_store_dwordx2 v[50:51], v5, s[64:67], s30 offen offset:128
  s_mov_b64 exec, s[36:37]
  s_add_u32 s30, s30, 36864
  buffer_store_dwordx4 v[38:41], v4, s[64:67], s30 offen offset:0
  v_cmp_gt_u32 vcc, 2, v3
  s_and_saveexec_b64 s[36:37], vcc
  buffer_store_dwordx2 v[54:55], v5, s[64:67], s30 offen offset:128
  s_mov_b64 exec, s[36:37]
  s_add_u32 s30, s30, 36864
  buffer_store_dwordx4 v[42:45], v4, s[64:67], s30 offen offset:0
  v_cmp_gt_u32 vcc, 2, v3
  s_and_saveexec_b64 s[36:37], vcc
  buffer_store_dwordx2 v[58:59], v5, s[64:67], s30 offen offset:128
  s_mov_b64 exec, s[36:37]
  s_add_u32 s30, s30, 36864
  buffer_store_dwordx4 v[46:49], v4, s[64:67], s30 offen offset:0
  v_cmp_gt_u32 vcc, 2, v3
  s_and_saveexec_b64 s[36:37], vcc
  buffer_store_dwordx2 v[62:63], v5, s[64:67], s30 offen offset:128
  s_mov_b64 exec, s[36:37]
  s_branch Lt3e_19
Lt3c_20:
  v_lshl_add_u32 v26, v5, 3, v4
  v_add_u32 v26, 64, v26
  v_lshl_add_u32 v27, v5, 3, v4
  v_add_u32 v27, 96, v27
  v_mov_b32 v92, 0
  v_mov_b32 v93, 0
  v_mov_b32 v94, 0
  v_mov_b32 v95, 0
  v_mov_b32 v96, 0
  v_mov_b32 v97, 0
  v_mov_b32 v98, 0
  v_mov_b32 v99, 0
  v_mov_b32 v104, 0
  v_mov_b32 v105, 0
  v_mov_b32 v106, 0
  v_mov_b32 v107, 0
  v_mov_b32 v108, 0
  v_mov_b32 v109, 0
  v_mov_b32 v110, 0
  v_mov_b32 v111, 0
  v_mov_b32 v116, 0
  v_mov_b32 v117, 0
  v_mov_b32 v118, 0
  v_mov_b32 v119, 0
  v_mov_b32 v120, 0
  v_mov_b32 v121, 0
  v_mov_b32 v122, 0
  v_mov_b32 v123, 0
  v_mov_b32 v128, 0
  v_mov_b32 v129, 0
  v_mov_b32 v130, 0
  v_mov_b32 v131, 0
  v_mov_b32 v132, 0
  v_mov_b32 v133, 0
  v_mov_b32 v134, 0
  v_mov_b32 v135, 0
  s_mov_b32 s46, 0
  s_mov_b32 s27, 0
  v_mov_b32 v3, 148480
  v_mov_b32 v4, 1
  s_lshl_b32 s30, s17, 3
  s_add_u32 s30, s30, s19
  s_lshl_b32 s30, s30, 4
  s_add_u32 s30, s30, s18
  s_lshl_b32 s30, s30, 7
  s_add_u32 s30, s30, 9437184
  v_mov_b32 v2, s30
  s_waitcnt vmcnt(0)
  v_cmp_eq_u32 vcc, 0, v1
  s_and_saveexec_b64 s[36:37], vcc
  ds_add_rtn_u32 v4, v3, v4 offset:12
  ds_read_b32 v3, v3
  s_waitcnt lgkmcnt(0)
  v_cmp_eq_u32 vcc, 7, v4
  s_and_b64 exec, exec, vcc
  s_cbranch_execz Lfo_24
  buffer_store_dword v3, v2, s[56:59], 0 offen sc1
Lfo_24:
  s_mov_b64 exec, s[36:37]
  s_barrier
  ds_read_b64_tr_b16 v[66:67], v26 offset:0
  ds_read_b64_tr_b16 v[68:69], v26 offset:2304
  ds_read_b128 v[34:37], v24 offset:0
  ds_read_b128 v[38:41], v24 offset:2048
  ds_read_b128 v[42:45], v24 offset:4096
  ds_read_b128 v[46:49], v24 offset:6144
  ds_read_b64_tr_b16 v[70:71], v27 offset:0
  ds_read_b64_tr_b16 v[72:73], v27 offset:2304
concat_heads__mha_block__mha_block__prompt_kernel_t3l1:
  s_waitcnt lgkmcnt(2)
  v_mfma_f32_16x16x32_bf16 v[92:95], v[66:69], v[34:37], v[92:95]
  ds_read_b64_tr_b16 v[78:79], v26 offset:4608
  ds_read_b64_tr_b16 v[80:81], v26 offset:6912
  v_mfma_f32_16x16x32_bf16 v[104:107], v[66:69], v[38:41], v[104:107]
  ds_read_b128 v[50:53], v25 offset:0
  ds_read_b128 v[54:57], v25 offset:2048
  v_mfma_f32_16x16x32_bf16 v[116:119], v[66:69], v[42:45], v[116:119]
  ds_read_b128 v[58:61], v25 offset:4096
  ds_read_b128 v[62:65], v25 offset:6144
  v_mfma_f32_16x16x32_bf16 v[128:131], v[66:69], v[46:49], v[128:131]
  ds_read_b64_tr_b16 v[82:83], v27 offset:4608
  ds_read_b64_tr_b16 v[84:85], v27 offset:6912
  s_waitcnt lgkmcnt(8)
  v_mfma_f32_16x16x32_bf16 v[96:99], v[70:73], v[34:37], v[96:99]
  v_mfma_f32_16x16x32_bf16 v[108:111], v[70:73], v[38:41], v[108:111]
  v_mfma_f32_16x16x32_bf16 v[120:123], v[70:73], v[42:45], v[120:123]
  v_mfma_f32_16x16x32_bf16 v[132:135], v[70:73], v[46:49], v[132:135]
  s_add_u32 s46, s46, 1
  s_cmp_eq_u32 s46, 4
  s_mov_b32 s47, 16384
  s_cmov_b32 s47, 4294918144
  s_cselect_b32 s46, 0, s46
  s_waitcnt lgkmcnt(0)
  s_barrier
  v_add_u32 v24, s47, v24
  v_add_u32 v25, s47, v25
  s_cmp_eq_u32 s27, 6
  s_mov_b32 s47, 9216
  s_cmov_b32 s47, 4294828032
  v_add_u32 v26, s47, v26
  v_add_u32 v27, s47, v27
  s_add_u32 s27, s27, 1
  s_cmp_lt_u32 s27, 8
  s_cbranch_scc0 Lt3p_25
  v_mfma_f32_16x16x32_bf16 v[92:95], v[78:81], v[50:53], v[92:95]
  ds_read_b64_tr_b16 v[66:67], v26 offset:0
  ds_read_b64_tr_b16 v[68:69], v26 offset:2304
  v_mfma_f32_16x16x32_bf16 v[104:107], v[78:81], v[54:57], v[104:107]
  ds_read_b128 v[34:37], v24 offset:0
  ds_read_b128 v[38:41], v24 offset:2048
  v_mfma_f32_16x16x32_bf16 v[116:119], v[78:81], v[58:61], v[116:119]
  ds_read_b128 v[42:45], v24 offset:4096
  ds_read_b128 v[46:49], v24 offset:6144
  v_mfma_f32_16x16x32_bf16 v[128:131], v[78:81], v[62:65], v[128:131]
  ds_read_b64_tr_b16 v[70:71], v27 offset:0
  ds_read_b64_tr_b16 v[72:73], v27 offset:2304
  v_mfma_f32_16x16x32_bf16 v[96:99], v[82:85], v[50:53], v[96:99]
  v_mfma_f32_16x16x32_bf16 v[108:111], v[82:85], v[54:57], v[108:111]
  v_mfma_f32_16x16x32_bf16 v[120:123], v[82:85], v[58:61], v[120:123]
  v_mfma_f32_16x16x32_bf16 v[132:135], v[82:85], v[62:65], v[132:135]
  s_branch concat_heads__mha_block__mha_block__prompt_kernel_t3l1
Lt3p_25:
  v_mfma_f32_16x16x32_bf16 v[92:95], v[78:81], v[50:53], v[92:95]
  ds_read_b64_tr_b16 v[66:67], v26 offset:0
  ds_read_b64_tr_b16 v[68:69], v26 offset:2304
  ds_read2_b32 v[34:35], v29 offset0:0 offset1:128
  v_mfma_f32_16x16x32_bf16 v[104:107], v[78:81], v[54:57], v[104:107]
  ds_read2_b32 v[36:37], v30 offset0:0 offset1:128
  ds_read2_b32 v[38:39], v29 offset0:16 offset1:144
  ds_read2_b32 v[40:41], v30 offset0:16 offset1:144
  v_mfma_f32_16x16x32_bf16 v[116:119], v[78:81], v[58:61], v[116:119]
  ds_read2_b32 v[42:43], v29 offset0:32 offset1:160
  ds_read2_b32 v[44:45], v30 offset0:32 offset1:160
  ds_read2_b32 v[46:47], v29 offset0:48 offset1:176
  v_mfma_f32_16x16x32_bf16 v[128:131], v[78:81], v[62:65], v[128:131]
  ds_read2_b32 v[48:49], v30 offset0:48 offset1:176
  ds_read_b64_tr_b16 v[70:71], v27 offset:0
  ds_read_b64_tr_b16 v[72:73], v27 offset:2304
  v_mfma_f32_16x16x32_bf16 v[96:99], v[82:85], v[50:53], v[96:99]
  v_mfma_f32_16x16x32_bf16 v[108:111], v[82:85], v[54:57], v[108:111]
  v_mfma_f32_16x16x32_bf16 v[120:123], v[82:85], v[58:61], v[120:123]
  v_mfma_f32_16x16x32_bf16 v[132:135], v[82:85], v[62:65], v[132:135]
  s_waitcnt lgkmcnt(2)
  v_mfma_f32_16x16x32_bf16 v[92:95], v[66:69], v[34:37], v[92:95]
  ds_read_b64_tr_b16 v[78:79], v26 offset:4608
  ds_read_b64_tr_b16 v[80:81], v26 offset:6912
  ds_read2_b32 v[50:51], v31 offset0:0 offset1:128
  v_mfma_f32_16x16x32_bf16 v[104:107], v[66:69], v[38:41], v[104:107]
  ds_read2_b32 v[52:53], v32 offset0:0 offset1:128
  ds_read2_b32 v[54:55], v31 offset0:16 offset1:144
  ds_read2_b32 v[56:57], v32 offset0:16 offset1:144
  v_mfma_f32_16x16x32_bf16 v[116:119], v[66:69], v[42:45], v[116:119]
  ds_read2_b32 v[58:59], v31 offset0:32 offset1:160
  ds_read2_b32 v[60:61], v32 offset0:32 offset1:160
  ds_read2_b32 v[62:63], v31 offset0:48 offset1:176
  v_mfma_f32_16x16x32_bf16 v[128:131], v[66:69], v[46:49], v[128:131]
  ds_read2_b32 v[64:65], v32 offset0:48 offset1:176
  ds_read_b64_tr_b16 v[82:83], v27 offset:4608
  ds_read_b64_tr_b16 v[84:85], v27 offset:6912
  s_waitcnt lgkmcnt(12)
  v_mfma_f32_16x16x32_bf16 v[96:99], v[70:73], v[34:37], v[96:99]
  v_mfma_f32_16x16x32_bf16 v[108:111], v[70:73], v[38:41], v[108:111]
  v_mfma_f32_16x16x32_bf16 v[120:123], v[70:73], v[42:45], v[120:123]
  v_mfma_f32_16x16x32_bf16 v[132:135], v[70:73], v[46:49], v[132:135]
  s_waitcnt lgkmcnt(0)
  s_barrier
  v_mfma_f32_16x16x32_bf16 v[92:95], v[78:81], v[50:53], v[92:95]
  v_mfma_f32_16x16x32_bf16 v[104:107], v[78:81], v[54:57], v[104:107]
  v_mfma_f32_16x16x32_bf16 v[116:119], v[78:81], v[58:61], v[116:119]
  v_mfma_f32_16x16x32_bf16 v[128:131], v[78:81], v[62:65], v[128:131]
  v_mfma_f32_16x16x32_bf16 v[96:99], v[82:85], v[50:53], v[96:99]
  v_mfma_f32_16x16x32_bf16 v[108:111], v[82:85], v[54:57], v[108:111]
  v_mfma_f32_16x16x32_bf16 v[120:123], v[82:85], v[58:61], v[120:123]
  v_mfma_f32_16x16x32_bf16 v[132:135], v[82:85], v[62:65], v[132:135]
  s_nop 7
  v_and_b32 v2, 15, v1
  s_lshl_b32 s30, s19, 8
  s_lshr_b32 s31, s18, 3
  s_lshl_b32 s31, s31, 7
  s_add_u32 s30, s30, s31
  s_and_b32 s31, s16, 1
  s_lshl_b32 s31, s31, 6
  s_add_u32 s30, s30, s31
  v_add_u32 v2, s30, v2
  v_mul_u32_u24 v2, 2304, v2
  v_lshrrev_b32 v3, 4, v1
  s_mul_i32 s30, s17, 1152
  s_and_b32 s31, s18, 7
  s_mul_i32 s31, s31, 144
  s_add_u32 s30, s30, s31
  v_and_b32 v4, 1, v3
  v_lshlrev_b32 v4, 5, v4
  v_lshrrev_b32 v5, 1, v3
  v_lshl_add_u32 v4, v5, 4, v4
  v_add_u32 v4, v4, v2
  v_lshl_add_u32 v5, v3, 3, v2
  v_cvt_pk_bf16_f32 v34, v92, v93
  v_cvt_pk_bf16_f32 v35, v94, v95
  v_cvt_pk_bf16_f32 v36, v96, v97
  v_cvt_pk_bf16_f32 v37, v98, v99
  v_cvt_pk_bf16_f32 v38, v104, v105
  v_cvt_pk_bf16_f32 v39, v106, v107
  v_cvt_pk_bf16_f32 v40, v108, v109
  v_cvt_pk_bf16_f32 v41, v110, v111
  v_cvt_pk_bf16_f32 v42, v116, v117
  v_cvt_pk_bf16_f32 v43, v118, v119
  v_cvt_pk_bf16_f32 v44, v120, v121
  v_cvt_pk_bf16_f32 v45, v122, v123
  v_cvt_pk_bf16_f32 v46, v128, v129
  v_cvt_pk_bf16_f32 v47, v130, v131
  v_cvt_pk_bf16_f32 v48, v132, v133
  v_cvt_pk_bf16_f32 v49, v134, v135
  s_nop 1
  v_permlane16_swap_b32 v34, v36
  v_permlane16_swap_b32 v35, v37
  v_permlane16_swap_b32 v38, v40
  v_permlane16_swap_b32 v39, v41
  v_permlane16_swap_b32 v42, v44
  v_permlane16_swap_b32 v43, v45
  v_permlane16_swap_b32 v46, v48
  v_permlane16_swap_b32 v47, v49
  s_nop 1
  buffer_store_dwordx4 v[34:37], v4, s[64:67], s30 offen offset:64
  s_add_u32 s30, s30, 36864
  buffer_store_dwordx4 v[38:41], v4, s[64:67], s30 offen offset:64
  s_add_u32 s30, s30, 36864
  buffer_store_dwordx4 v[42:45], v4, s[64:67], s30 offen offset:64
  s_add_u32 s30, s30, 36864
  buffer_store_dwordx4 v[46:49], v4, s[64:67], s30 offen offset:64
Lt3e_19:
  s_branch concat_heads__mha_block__mha_block__prompt_kernel_fin
concat_heads__mha_block__mha_block__prompt_kernel_loader:
  s_setprio 3
  s_sub_u32 s38, s16, 8
  s_cmp_eq_u32 s38, 0
  s_cbranch_scc0 Lpf8_27
  s_lshl_b32 s30, s18, 1
  s_and_b32 s31, s19, 1
  s_add_u32 s30, s30, s31
  v_lshrrev_b32 v5, 4, v1
  v_add_u32 v5, 0, v5
  v_min_u32 v5, 1, v5
  v_and_b32 v2, 15, v1
  s_lshr_b32 s31, s19, 1
  s_lshl_b32 s31, s31, 9
  s_lshl_b32 s32, s30, 4
  s_add_u32 s31, s31, s32
  v_add_u32 v2, s31, v2
  v_mul_u32_u24 v2, 1152, v2
  v_lshl_add_u32 v2, v5, 7, v2
  buffer_load_dword v39, v2, s[56:59], 0 offen
  s_branch Lpf8_26
Lpf8_27:
  s_cmp_eq_u32 s38, 1
  s_cbranch_scc0 Lpf8_28
  s_lshl_b32 s30, s18, 1
  s_and_b32 s31, s19, 1
  s_add_u32 s30, s30, s31
  v_min_u32 v2, 53, v1
  s_mul_i32 s31, s30, 54
  v_add_u32 v2, s31, v2
  v_mul_u32_u24 v3, 2428, v2
  v_lshrrev_b32 v3, 16, v3
  v_mul_u32_u24 v4, 27, v3
  v_sub_u32 v4, v2, v4
  v_add_u32 v3, 0, v3
  v_mul_u32_u24 v3, 3456, v3
  v_lshl_add_u32 v3, v4, 7, v3
  buffer_load_dword v39, v3, s[60:63], 0 offen
  s_branch Lpf8_26
Lpf8_28:
  s_cmp_eq_u32 s38, 2
  s_cbranch_scc0 Lpf8_29
  s_lshl_b32 s30, s18, 1
  s_and_b32 s31, s19, 1
  s_add_u32 s30, s30, s31
  v_min_u32 v2, 53, v1
  s_mul_i32 s31, s30, 54
  v_add_u32 v2, s31, v2
  v_mul_u32_u24 v3, 2428, v2
  v_lshrrev_b32 v3, 16, v3
  v_mul_u32_u24 v4, 27, v3
  v_sub_u32 v4, v2, v4
  v_add_u32 v3, 64, v3
  v_mul_u32_u24 v3, 3456, v3
  v_lshl_add_u32 v3, v4, 7, v3
  buffer_load_dword v39, v3, s[60:63], 0 offen
  s_branch Lpf8_26
Lpf8_29:
Lpf8_26:
  v_lshrrev_b32 v2, 3, v1
  v_and_b32 v3, 7, v1
  v_lshrrev_b32 v4, 4, v1
  v_and_b32 v4, 1, v4
  s_lshl_b32 s30, s19, 8
  s_lshl_b32 s31, s38, 6
  s_add_u32 s30, s30, s31
  v_add_u32 v2, s30, v2
  v_mul_u32_u24 v2, 1152, v2
  v_or_b32 v5, 0, v4
  v_xor_b32 v5, v5, v3
  v_lshl_add_u32 v24, v5, 4, v2
  v_or_b32 v5, 2, v4
  v_xor_b32 v5, v5, v3
  v_lshl_add_u32 v25, v5, 4, v2
  v_add_u32 v25, 9216, v25
  v_or_b32 v5, 4, v4
  v_xor_b32 v5, v5, v3
  v_lshl_add_u32 v26, v5, 4, v2
  v_add_u32 v26, 18432, v26
  v_or_b32 v5, 6, v4
  v_xor_b32 v5, v5, v3
  v_lshl_add_u32 v27, v5, 4, v2
  v_add_u32 v27, 27648, v27
  v_lshrrev_b32 v2, 4, v1
  s_lshl_b32 s30, s38, 4
  v_add_u32 v7, s30, v2
  v_mul_u32_u24 v7, 3456, v7
  s_mul_i32 s30, s18, 72
  v_add_u32 v7, s30, v7
  v_or_b32 v3, 0, v2
  v_lshlrev_b32 v3, 1, v3
  v_and_b32 v4, 15, v1
  v_xor_b32 v4, v4, v3
  v_lshrrev_b32 v5, 2, v4
  v_and_b32 v6, 3, v4
  v_min_u32 v3, 2, v6
  v_cmp_eq_u32 vcc, 3, v5
  s_nop 1
  v_cndmask_b32 v5, v5, v3, vcc
  v_lshlrev_b32 v6, 4, v6
  v_cndmask_b32 v6, v6, 56, vcc
  v_mul_u32_u24 v5, 1152, v5
  v_add3_u32 v28, v5, v6, v7
  v_or_b32 v3, 4, v2
  v_lshlrev_b32 v3, 1, v3
  v_and_b32 v4, 15, v1
  v_xor_b32 v4, v4, v3
  v_lshrrev_b32 v5, 2, v4
  v_and_b32 v6, 3, v4
  v_min_u32 v3, 2, v6
  v_cmp_eq_u32 vcc, 3, v5
  s_nop 1
  v_cndmask_b32 v5, v5, v3, vcc
  v_lshlrev_b32 v6, 4, v6
  v_cndmask_b32 v6, v6, 56, vcc
  v_mul_u32_u24 v5, 1152, v5
  v_add3_u32 v29, v5, v6, v7
  s_lshl_b32 s70, s38, 13
  s_lshl_b32 s71, s38, 12
  s_add_u32 s71, s71, 32768
  s_mov_b32 s67, 0
  s_mov_b32 s66, 0
  s_waitcnt vmcnt(0)
  s_lshl_b32 s64, s67, 7
  s_mul_i32 s65, s67, 221184
  s_add_u32 s30, s66, s71
  s_add_u32 m0, s30, 0
  s_add_u32 s31, s65, 0
  buffer_load_dwordx4 v28, s[60:63], s31 offen lds
  s_add_u32 s30, s66, s71
  s_add_u32 m0, s30, 1024
  s_add_u32 s31, s65, 13824
  buffer_load_dwordx4 v28, s[60:63], s31 offen lds
  s_add_u32 s30, s66, s71
  s_add_u32 m0, s30, 2048
  s_add_u32 s31, s65, 27648
  buffer_load_dwordx4 v29, s[60:63], s31 offen lds
  s_add_u32 s30, s66, s71
  s_add_u32 m0, s30, 3072
  s_add_u32 s31, s65, 41472
  buffer_load_dwordx4 v29, s[60:63], s31 offen lds
  s_add_u32 s30, s66, s70
  s_add_u32 m0, s30, 0
  s_add_u32 s31, s64, 0
  buffer_load_dwordx4 v24, s[56:59], s31 offen lds
  s_add_u32 s30, s66, s70
  s_add_u32 m0, s30, 1024
  s_add_u32 s31, s64, 0
  buffer_load_dwordx4 v25, s[56:59], s31 offen lds
  s_add_u32 s30, s66, s70
  s_add_u32 m0, s30, 2048
  s_add_u32 s31, s64, 0
  buffer_load_dwordx4 v26, s[56:59], s31 offen lds
  s_add_u32 s30, s66, s70
  s_add_u32 m0, s30, 3072
  s_add_u32 s31, s64, 0
  buffer_load_dwordx4 v27, s[56:59], s31 offen lds
  s_add_u32 s30, s66, s70
  s_add_u32 m0, s30, 4096
  s_add_u32 s31, s64, 36864
  buffer_load_dwordx4 v24, s[56:59], s31 offen lds
  s_add_u32 s30, s66, s70
  s_add_u32 m0, s30, 5120
  s_add_u32 s31, s64, 36864
  buffer_load_dwordx4 v25, s[56:59], s31 offen lds
  s_add_u32 s30, s66, s70
  s_add_u32 m0, s30, 6144
  s_add_u32 s31, s64, 36864
  buffer_load_dwordx4 v26, s[56:59], s31 offen lds
  s_add_u32 s30, s66, s70
  s_add_u32 m0, s30, 7168
  s_add_u32 s31, s64, 36864
  buffer_load_dwordx4 v27, s[56:59], s31 offen lds
  s_add_u32 s67, s67, 1
  s_add_u32 s66, s66, 49152
  s_cmp_eq_u32 s66, 147456
  s_cselect_b32 s66, 0, s66
  s_lshl_b32 s64, s67, 7
  s_mul_i32 s65, s67, 221184
  s_add_u32 s30, s66, s71
  s_add_u32 m0, s30, 0
  s_add_u32 s31, s65, 0
  buffer_load_dwordx4 v28, s[60:63], s31 offen lds
  s_add_u32 s30, s66, s71
  s_add_u32 m0, s30, 1024
  s_add_u32 s31, s65, 13824
  buffer_load_dwordx4 v28, s[60:63], s31 offen lds
  s_add_u32 s30, s66, s71
  s_add_u32 m0, s30, 2048
  s_add_u32 s31, s65, 27648
  buffer_load_dwordx4 v29, s[60:63], s31 offen lds
  s_add_u32 s30, s66, s71
  s_add_u32 m0, s30, 3072
  s_add_u32 s31, s65, 41472
  buffer_load_dwordx4 v29, s[60:63], s31 offen lds
  s_add_u32 s30, s66, s70
  s_add_u32 m0, s30, 0
  s_add_u32 s31, s64, 0
  buffer_load_dwordx4 v24, s[56:59], s31 offen lds
  s_add_u32 s30, s66, s70
  s_add_u32 m0, s30, 1024
  s_add_u32 s31, s64, 0
  buffer_load_dwordx4 v25, s[56:59], s31 offen lds
  s_add_u32 s30, s66, s70
  s_add_u32 m0, s30, 2048
  s_add_u32 s31, s64, 0
  buffer_load_dwordx4 v26, s[56:59], s31 offen lds
  s_add_u32 s30, s66, s70
  s_add_u32 m0, s30, 3072
  s_add_u32 s31, s64, 0
  buffer_load_dwordx4 v27, s[56:59], s31 offen lds
  s_add_u32 s30, s66, s70
  s_add_u32 m0, s30, 4096
  s_add_u32 s31, s64, 36864
  buffer_load_dwordx4 v24, s[56:59], s31 offen lds
  s_add_u32 s30, s66, s70
  s_add_u32 m0, s30, 5120
  s_add_u32 s31, s64, 36864
  buffer_load_dwordx4 v25, s[56:59], s31 offen lds
  s_add_u32 s30, s66, s70
  s_add_u32 m0, s30, 6144
  s_add_u32 s31, s64, 36864
  buffer_load_dwordx4 v26, s[56:59], s31 offen lds
  s_add_u32 s30, s66, s70
  s_add_u32 m0, s30, 7168
  s_add_u32 s31, s64, 36864
  buffer_load_dwordx4 v27, s[56:59], s31 offen lds
  s_add_u32 s67, s67, 1
  s_add_u32 s66, s66, 49152
  s_cmp_eq_u32 s66, 147456
  s_cselect_b32 s66, 0, s66
  s_waitcnt vmcnt(12)
  s_barrier
  s_lshl_b32 s64, s67, 7
  s_mul_i32 s65, s67, 221184
  s_add_u32 s30, s66, s71
  s_add_u32 m0, s30, 0
  s_add_u32 s31, s65, 0
  buffer_load_dwordx4 v28, s[60:63], s31 offen lds
  s_add_u32 s30, s66, s71
  s_add_u32 m0, s30, 1024
  s_add_u32 s31, s65, 13824
  buffer_load_dwordx4 v28, s[60:63], s31 offen lds
  s_add_u32 s30, s66, s71
  s_add_u32 m0, s30, 2048
  s_add_u32 s31, s65, 27648
  buffer_load_dwordx4 v29, s[60:63], s31 offen lds
  s_add_u32 s30, s66, s71
  s_add_u32 m0, s30, 3072
  s_add_u32 s31, s65, 41472
  buffer_load_dwordx4 v29, s[60:63], s31 offen lds
  s_add_u32 s30, s66, s70
  s_add_u32 m0, s30, 0
  s_add_u32 s31, s64, 0
  buffer_load_dwordx4 v24, s[56:59], s31 offen lds
  s_add_u32 s30, s66, s70
  s_add_u32 m0, s30, 1024
  s_add_u32 s31, s64, 0
  buffer_load_dwordx4 v25, s[56:59], s31 offen lds
  s_add_u32 s30, s66, s70
  s_add_u32 m0, s30, 2048
  s_add_u32 s31, s64, 0
  buffer_load_dwordx4 v26, s[56:59], s31 offen lds
  s_add_u32 s30, s66, s70
  s_add_u32 m0, s30, 3072
  s_add_u32 s31, s64, 0
  buffer_load_dwordx4 v27, s[56:59], s31 offen lds
  s_add_u32 s30, s66, s70
  s_add_u32 m0, s30, 4096
  s_add_u32 s31, s64, 36864
  buffer_load_dwordx4 v24, s[56:59], s31 offen lds
  s_add_u32 s30, s66, s70
  s_add_u32 m0, s30, 5120
  s_add_u32 s31, s64, 36864
  buffer_load_dwordx4 v25, s[56:59], s31 offen lds
  s_add_u32 s30, s66, s70
  s_add_u32 m0, s30, 6144
  s_add_u32 s31, s64, 36864
  buffer_load_dwordx4 v26, s[56:59], s31 offen lds
  s_add_u32 s30, s66, s70
  s_add_u32 m0, s30, 7168
  s_add_u32 s31, s64, 36864
  buffer_load_dwordx4 v27, s[56:59], s31 offen lds
  s_add_u32 s67, s67, 1
  s_add_u32 s66, s66, 49152
  s_cmp_eq_u32 s66, 147456
  s_cselect_b32 s66, 0, s66
  s_waitcnt vmcnt(12)
  s_barrier
  s_lshl_b32 s64, s67, 7
  s_mul_i32 s65, s67, 221184
  s_add_u32 s30, s66, s71
  s_add_u32 m0, s30, 0
  s_add_u32 s31, s65, 0
  buffer_load_dwordx4 v28, s[60:63], s31 offen lds
  s_add_u32 s30, s66, s71
  s_add_u32 m0, s30, 1024
  s_add_u32 s31, s65, 13824
  buffer_load_dwordx4 v28, s[60:63], s31 offen lds
  s_add_u32 s30, s66, s71
  s_add_u32 m0, s30, 2048
  s_add_u32 s31, s65, 27648
  buffer_load_dwordx4 v29, s[60:63], s31 offen lds
  s_add_u32 s30, s66, s71
  s_add_u32 m0, s30, 3072
  s_add_u32 s31, s65, 41472
  buffer_load_dwordx4 v29, s[60:63], s31 offen lds
  s_add_u32 s30, s66, s70
  s_add_u32 m0, s30, 0
  s_add_u32 s31, s64, 0
  buffer_load_dwordx4 v24, s[56:59], s31 offen lds
  s_add_u32 s30, s66, s70
  s_add_u32 m0, s30, 1024
  s_add_u32 s31, s64, 0
  buffer_load_dwordx4 v25, s[56:59], s31 offen lds
  s_add_u32 s30, s66, s70
  s_add_u32 m0, s30, 2048
  s_add_u32 s31, s64, 0
  buffer_load_dwordx4 v26, s[56:59], s31 offen lds
  s_add_u32 s30, s66, s70
  s_add_u32 m0, s30, 3072
  s_add_u32 s31, s64, 0
  buffer_load_dwordx4 v27, s[56:59], s31 offen lds
  s_add_u32 s30, s66, s70
  s_add_u32 m0, s30, 4096
  s_add_u32 s31, s64, 36864
  buffer_load_dwordx4 v24, s[56:59], s31 offen lds
  s_add_u32 s30, s66, s70
  s_add_u32 m0, s30, 5120
  s_add_u32 s31, s64, 36864
  buffer_load_dwordx4 v25, s[56:59], s31 offen lds
  s_add_u32 s30, s66, s70
  s_add_u32 m0, s30, 6144
  s_add_u32 s31, s64, 36864
  buffer_load_dwordx4 v26, s[56:59], s31 offen lds
  s_add_u32 s30, s66, s70
  s_add_u32 m0, s30, 7168
  s_add_u32 s31, s64, 36864
  buffer_load_dwordx4 v27, s[56:59], s31 offen lds
  s_add_u32 s67, s67, 1
  s_add_u32 s66, s66, 49152
  s_cmp_eq_u32 s66, 147456
  s_cselect_b32 s66, 0, s66
  s_waitcnt vmcnt(12)
  s_barrier
  s_lshl_b32 s64, s67, 7
  s_mul_i32 s65, s67, 221184
  s_add_u32 s30, s66, s71
  s_add_u32 m0, s30, 0
  s_add_u32 s31, s65, 0
  buffer_load_dwordx4 v28, s[60:63], s31 offen lds
  s_add_u32 s30, s66, s71
  s_add_u32 m0, s30, 1024
  s_add_u32 s31, s65, 13824
  buffer_load_dwordx4 v28, s[60:63], s31 offen lds
  s_add_u32 s30, s66, s71
  s_add_u32 m0, s30, 2048
  s_add_u32 s31, s65, 27648
  buffer_load_dwordx4 v29, s[60:63], s31 offen lds
  s_add_u32 s30, s66, s71
  s_add_u32 m0, s30, 3072
  s_add_u32 s31, s65, 41472
  buffer_load_dwordx4 v29, s[60:63], s31 offen lds
  s_add_u32 s30, s66, s70
  s_add_u32 m0, s30, 0
  s_add_u32 s31, s64, 0
  buffer_load_dwordx4 v24, s[56:59], s31 offen lds
  s_add_u32 s30, s66, s70
  s_add_u32 m0, s30, 1024
  s_add_u32 s31, s64, 0
  buffer_load_dwordx4 v25, s[56:59], s31 offen lds
  s_add_u32 s30, s66, s70
  s_add_u32 m0, s30, 2048
  s_add_u32 s31, s64, 0
  buffer_load_dwordx4 v26, s[56:59], s31 offen lds
  s_add_u32 s30, s66, s70
  s_add_u32 m0, s30, 3072
  s_add_u32 s31, s64, 0
  buffer_load_dwordx4 v27, s[56:59], s31 offen lds
  s_add_u32 s30, s66, s70
  s_add_u32 m0, s30, 4096
  s_add_u32 s31, s64, 36864
  buffer_load_dwordx4 v24, s[56:59], s31 offen lds
  s_add_u32 s30, s66, s70
  s_add_u32 m0, s30, 5120
  s_add_u32 s31, s64, 36864
  buffer_load_dwordx4 v25, s[56:59], s31 offen lds
  s_add_u32 s30, s66, s70
  s_add_u32 m0, s30, 6144
  s_add_u32 s31, s64, 36864
  buffer_load_dwordx4 v26, s[56:59], s31 offen lds
  s_add_u32 s30, s66, s70
  s_add_u32 m0, s30, 7168
  s_add_u32 s31, s64, 36864
  buffer_load_dwordx4 v27, s[56:59], s31 offen lds
  s_add_u32 s67, s67, 1
  s_add_u32 s66, s66, 49152
  s_cmp_eq_u32 s66, 147456
  s_cselect_b32 s66, 0, s66
  s_waitcnt vmcnt(12)
  s_barrier
  s_lshl_b32 s64, s67, 7
  s_mul_i32 s65, s67, 221184
  s_add_u32 s30, s66, s71
  s_add_u32 m0, s30, 0
  s_add_u32 s31, s65, 0
  buffer_load_dwordx4 v28, s[60:63], s31 offen lds
  s_add_u32 s30, s66, s71
  s_add_u32 m0, s30, 1024
  s_add_u32 s31, s65, 13824
  buffer_load_dwordx4 v28, s[60:63], s31 offen lds
  s_add_u32 s30, s66, s71
  s_add_u32 m0, s30, 2048
  s_add_u32 s31, s65, 27648
  buffer_load_dwordx4 v29, s[60:63], s31 offen lds
  s_add_u32 s30, s66, s71
  s_add_u32 m0, s30, 3072
  s_add_u32 s31, s65, 41472
  buffer_load_dwordx4 v29, s[60:63], s31 offen lds
  s_add_u32 s30, s66, s70
  s_add_u32 m0, s30, 0
  s_add_u32 s31, s64, 0
  buffer_load_dwordx4 v24, s[56:59], s31 offen lds
  s_add_u32 s30, s66, s70
  s_add_u32 m0, s30, 1024
  s_add_u32 s31, s64, 0
  buffer_load_dwordx4 v25, s[56:59], s31 offen lds
  s_add_u32 s30, s66, s70
  s_add_u32 m0, s30, 2048
  s_add_u32 s31, s64, 0
  buffer_load_dwordx4 v26, s[56:59], s31 offen lds
  s_add_u32 s30, s66, s70
  s_add_u32 m0, s30, 3072
  s_add_u32 s31, s64, 0
  buffer_load_dwordx4 v27, s[56:59], s31 offen lds
  s_add_u32 s30, s66, s70
  s_add_u32 m0, s30, 4096
  s_add_u32 s31, s64, 36864
  buffer_load_dwordx4 v24, s[56:59], s31 offen lds
  s_add_u32 s30, s66, s70
  s_add_u32 m0, s30, 5120
  s_add_u32 s31, s64, 36864
  buffer_load_dwordx4 v25, s[56:59], s31 offen lds
  s_add_u32 s30, s66, s70
  s_add_u32 m0, s30, 6144
  s_add_u32 s31, s64, 36864
  buffer_load_dwordx4 v26, s[56:59], s31 offen lds
  s_add_u32 s30, s66, s70
  s_add_u32 m0, s30, 7168
  s_add_u32 s31, s64, 36864
  buffer_load_dwordx4 v27, s[56:59], s31 offen lds
  s_add_u32 s67, s67, 1
  s_add_u32 s66, s66, 49152
  s_cmp_eq_u32 s66, 147456
  s_cselect_b32 s66, 0, s66
  s_waitcnt vmcnt(12)
  s_barrier
  s_lshl_b32 s64, s67, 7
  s_mul_i32 s65, s67, 221184
  s_add_u32 s30, s66, s71
  s_add_u32 m0, s30, 0
  s_add_u32 s31, s65, 0
  buffer_load_dwordx4 v28, s[60:63], s31 offen lds
  s_add_u32 s30, s66, s71
  s_add_u32 m0, s30, 1024
  s_add_u32 s31, s65, 13824
  buffer_load_dwordx4 v28, s[60:63], s31 offen lds
  s_add_u32 s30, s66, s71
  s_add_u32 m0, s30, 2048
  s_add_u32 s31, s65, 27648
  buffer_load_dwordx4 v29, s[60:63], s31 offen lds
  s_add_u32 s30, s66, s71
  s_add_u32 m0, s30, 3072
  s_add_u32 s31, s65, 41472
  buffer_load_dwordx4 v29, s[60:63], s31 offen lds
  s_add_u32 s30, s66, s70
  s_add_u32 m0, s30, 0
  s_add_u32 s31, s64, 0
  buffer_load_dwordx4 v24, s[56:59], s31 offen lds
  s_add_u32 s30, s66, s70
  s_add_u32 m0, s30, 1024
  s_add_u32 s31, s64, 0
  buffer_load_dwordx4 v25, s[56:59], s31 offen lds
  s_add_u32 s30, s66, s70
  s_add_u32 m0, s30, 2048
  s_add_u32 s31, s64, 0
  buffer_load_dwordx4 v26, s[56:59], s31 offen lds
  s_add_u32 s30, s66, s70
  s_add_u32 m0, s30, 3072
  s_add_u32 s31, s64, 0
  buffer_load_dwordx4 v27, s[56:59], s31 offen lds
  s_add_u32 s30, s66, s70
  s_add_u32 m0, s30, 4096
  s_add_u32 s31, s64, 36864
  buffer_load_dwordx4 v24, s[56:59], s31 offen lds
  s_add_u32 s30, s66, s70
  s_add_u32 m0, s30, 5120
  s_add_u32 s31, s64, 36864
  buffer_load_dwordx4 v25, s[56:59], s31 offen lds
  s_add_u32 s30, s66, s70
  s_add_u32 m0, s30, 6144
  s_add_u32 s31, s64, 36864
  buffer_load_dwordx4 v26, s[56:59], s31 offen lds
  s_add_u32 s30, s66, s70
  s_add_u32 m0, s30, 7168
  s_add_u32 s31, s64, 36864
  buffer_load_dwordx4 v27, s[56:59], s31 offen lds
  s_add_u32 s67, s67, 1
  s_add_u32 s66, s66, 49152
  s_cmp_eq_u32 s66, 147456
  s_cselect_b32 s66, 0, s66
  s_waitcnt vmcnt(12)
  s_barrier
  s_lshl_b32 s64, s67, 7
  s_mul_i32 s65, s67, 221184
  s_add_u32 s30, s66, s71
  s_add_u32 m0, s30, 0
  s_add_u32 s31, s65, 0
  buffer_load_dwordx4 v28, s[60:63], s31 offen lds
  s_add_u32 s30, s66, s71
  s_add_u32 m0, s30, 1024
  s_add_u32 s31, s65, 13824
  buffer_load_dwordx4 v28, s[60:63], s31 offen lds
  s_add_u32 s30, s66, s71
  s_add_u32 m0, s30, 2048
  s_add_u32 s31, s65, 27648
  buffer_load_dwordx4 v29, s[60:63], s31 offen lds
  s_add_u32 s30, s66, s71
  s_add_u32 m0, s30, 3072
  s_add_u32 s31, s65, 41472
  buffer_load_dwordx4 v29, s[60:63], s31 offen lds
  s_add_u32 s30, s66, s70
  s_add_u32 m0, s30, 0
  s_add_u32 s31, s64, 0
  buffer_load_dwordx4 v24, s[56:59], s31 offen lds
  s_add_u32 s30, s66, s70
  s_add_u32 m0, s30, 1024
  s_add_u32 s31, s64, 0
  buffer_load_dwordx4 v25, s[56:59], s31 offen lds
  s_add_u32 s30, s66, s70
  s_add_u32 m0, s30, 2048
  s_add_u32 s31, s64, 0
  buffer_load_dwordx4 v26, s[56:59], s31 offen lds
  s_add_u32 s30, s66, s70
  s_add_u32 m0, s30, 3072
  s_add_u32 s31, s64, 0
  buffer_load_dwordx4 v27, s[56:59], s31 offen lds
  s_add_u32 s30, s66, s70
  s_add_u32 m0, s30, 4096
  s_add_u32 s31, s64, 36864
  buffer_load_dwordx4 v24, s[56:59], s31 offen lds
  s_add_u32 s30, s66, s70
  s_add_u32 m0, s30, 5120
  s_add_u32 s31, s64, 36864
  buffer_load_dwordx4 v25, s[56:59], s31 offen lds
  s_add_u32 s30, s66, s70
  s_add_u32 m0, s30, 6144
  s_add_u32 s31, s64, 36864
  buffer_load_dwordx4 v26, s[56:59], s31 offen lds
  s_add_u32 s30, s66, s70
  s_add_u32 m0, s30, 7168
  s_add_u32 s31, s64, 36864
  buffer_load_dwordx4 v27, s[56:59], s31 offen lds
  s_add_u32 s67, s67, 1
  s_add_u32 s66, s66, 49152
  s_cmp_eq_u32 s66, 147456
  s_cselect_b32 s66, 0, s66
  s_waitcnt vmcnt(12)
  s_barrier
  s_lshl_b32 s64, s67, 7
  s_mul_i32 s65, s67, 221184
  s_add_u32 s30, s66, s71
  s_add_u32 m0, s30, 0
  s_add_u32 s31, s65, 0
  buffer_load_dwordx4 v28, s[60:63], s31 offen lds
  s_add_u32 s30, s66, s71
  s_add_u32 m0, s30, 1024
  s_add_u32 s31, s65, 13824
  buffer_load_dwordx4 v28, s[60:63], s31 offen lds
  s_add_u32 s30, s66, s71
  s_add_u32 m0, s30, 2048
  s_add_u32 s31, s65, 27648
  buffer_load_dwordx4 v29, s[60:63], s31 offen lds
  s_add_u32 s30, s66, s71
  s_add_u32 m0, s30, 3072
  s_add_u32 s31, s65, 41472
  buffer_load_dwordx4 v29, s[60:63], s31 offen lds
  s_add_u32 s30, s66, s70
  s_add_u32 m0, s30, 0
  s_add_u32 s31, s64, 0
  buffer_load_dwordx4 v24, s[56:59], s31 offen lds
  s_add_u32 s30, s66, s70
  s_add_u32 m0, s30, 1024
  s_add_u32 s31, s64, 0
  buffer_load_dwordx4 v25, s[56:59], s31 offen lds
  s_add_u32 s30, s66, s70
  s_add_u32 m0, s30, 2048
  s_add_u32 s31, s64, 0
  buffer_load_dwordx4 v26, s[56:59], s31 offen lds
  s_add_u32 s30, s66, s70
  s_add_u32 m0, s30, 3072
  s_add_u32 s31, s64, 0
  buffer_load_dwordx4 v27, s[56:59], s31 offen lds
  s_add_u32 s30, s66, s70
  s_add_u32 m0, s30, 4096
  s_add_u32 s31, s64, 36864
  buffer_load_dwordx4 v24, s[56:59], s31 offen lds
  s_add_u32 s30, s66, s70
  s_add_u32 m0, s30, 5120
  s_add_u32 s31, s64, 36864
  buffer_load_dwordx4 v25, s[56:59], s31 offen lds
  s_add_u32 s30, s66, s70
  s_add_u32 m0, s30, 6144
  s_add_u32 s31, s64, 36864
  buffer_load_dwordx4 v26, s[56:59], s31 offen lds
  s_add_u32 s30, s66, s70
  s_add_u32 m0, s30, 7168
  s_add_u32 s31, s64, 36864
  buffer_load_dwordx4 v27, s[56:59], s31 offen lds
  s_add_u32 s67, s67, 1
  s_add_u32 s66, s66, 49152
  s_cmp_eq_u32 s66, 147456
  s_cselect_b32 s66, 0, s66
  s_waitcnt vmcnt(12)
  s_barrier
  s_waitcnt vmcnt(0)
  s_barrier
  s_waitcnt vmcnt(0)
  s_barrier
  s_mul_i32 s30, s17, 7077888
  s_add_u32 s8, s4, s30
  s_addc_u32 s9, s5, 0
  s_mov_b32 s10, 7077888
  s_mov_b32 s11, 0x20000
  v_lshrrev_b32 v2, 5, v1
  v_and_b32 v3, 31, v1
  v_lshlrev_b32 v4, 2, v2
  v_xor_b32 v4, v4, v3
  v_lshlrev_b32 v4, 4, v4
  v_lshl_add_u32 v4, v2, 12, v4
  v_xor_b32 v5, v2, v3
  v_lshlrev_b32 v5, 4, v5
  v_lshl_add_u32 v5, v2, 12, v5
  s_add_u32 s30, s38, 0
  s_cmp_ge_u32 s30, 18
  s_cselect_b32 s31, 18, 0
  s_mov_b32 s32, 1152
  s_cmov_b32 s32, 1056
  s_cselect_b32 s33, 10496, 0
  s_mov_b32 s72, 576
  s_cmov_b32 s72, 1152
  s_cselect_b64 vcc, -1, 0
  s_sub_u32 s30, s30, s31
  s_mul_i32 s31, s18, 36
  s_add_u32 s72, s72, s31
  s_lshl_b32 s31, s30, 1
  s_add_u32 s72, s72, s31
  s_lshl_b32 s72, s72, 12
  v_cndmask_b32 v30, v4, v5, vcc
  v_add_u32 v30, s72, v30
  s_cmp_ge_u32 s30, 9
  s_cselect_b32 s31, 9, 0
  s_cselect_b32 s72, 20224, 0
  s_sub_u32 s30, s30, s31
  s_mul_i32 s30, s30, s32
  s_add_u32 s72, s72, s30
  s_add_u32 s72, s72, s33
  s_add_u32 s30, s38, 4
  s_cmp_ge_u32 s30, 18
  s_cselect_b32 s31, 18, 0
  s_mov_b32 s32, 1152
  s_cmov_b32 s32, 1056
  s_cselect_b32 s33, 10496, 0
  s_mov_b32 s73, 576
  s_cmov_b32 s73, 1152
  s_cselect_b64 vcc, -1, 0
  s_sub_u32 s30, s30, s31
  s_mul_i32 s31, s18, 36
  s_add_u32 s73, s73, s31
  s_lshl_b32 s31, s30, 1
  s_add_u32 s73, s73, s31
  s_lshl_b32 s73, s73, 12
  v_cndmask_b32 v31, v4, v5, vcc
  v_add_u32 v31, s73, v31
  s_cmp_ge_u32 s30, 9
  s_cselect_b32 s31, 9, 0
  s_cselect_b32 s73, 20224, 0
  s_sub_u32 s30, s30, s31
  s_mul_i32 s30, s30, s32
  s_add_u32 s73, s73, s30
  s_add_u32 s73, s73, s33
  s_add_u32 s30, s38, 8
  s_cmp_ge_u32 s30, 18
  s_cselect_b32 s31, 18, 0
  s_mov_b32 s32, 1152
  s_cmov_b32 s32, 1056
  s_cselect_b32 s33, 10496, 0
  s_mov_b32 s74, 576
  s_cmov_b32 s74, 1152
  s_cselect_b64 vcc, -1, 0
  s_sub_u32 s30, s30, s31
  s_mul_i32 s31, s18, 36
  s_add_u32 s74, s74, s31
  s_lshl_b32 s31, s30, 1
  s_add_u32 s74, s74, s31
  s_lshl_b32 s74, s74, 12
  v_cndmask_b32 v32, v4, v5, vcc
  v_add_u32 v32, s74, v32
  s_cmp_ge_u32 s30, 9
  s_cselect_b32 s31, 9, 0
  s_cselect_b32 s74, 20224, 0
  s_sub_u32 s30, s30, s31
  s_mul_i32 s30, s30, s32
  s_add_u32 s74, s74, s30
  s_add_u32 s74, s74, s33
  s_add_u32 s30, s38, 12
  s_cmp_ge_u32 s30, 18
  s_cselect_b32 s31, 18, 0
  s_mov_b32 s32, 1152
  s_cmov_b32 s32, 1056
  s_cselect_b32 s33, 10496, 0
  s_mov_b32 s75, 576
  s_cmov_b32 s75, 1152
  s_cselect_b64 vcc, -1, 0
  s_sub_u32 s30, s30, s31
  s_mul_i32 s31, s18, 36
  s_add_u32 s75, s75, s31
  s_lshl_b32 s31, s30, 1
  s_add_u32 s75, s75, s31
  s_lshl_b32 s75, s75, 12
  v_cndmask_b32 v33, v4, v5, vcc
  v_add_u32 v33, s75, v33
  s_cmp_ge_u32 s30, 9
  s_cselect_b32 s31, 9, 0
  s_cselect_b32 s75, 20224, 0
  s_sub_u32 s30, s30, s31
  s_mul_i32 s30, s30, s32
  s_add_u32 s75, s75, s30
  s_add_u32 s75, s75, s33
  s_add_u32 s30, s38, 16
  s_cmp_ge_u32 s30, 18
  s_cselect_b32 s31, 18, 0
  s_mov_b32 s32, 1152
  s_cmov_b32 s32, 1056
  s_cselect_b32 s33, 10496, 0
  s_mov_b32 s76, 576
  s_cmov_b32 s76, 1152
  s_cselect_b64 vcc, -1, 0
  s_sub_u32 s30, s30, s31
  s_mul_i32 s31, s18, 36
  s_add_u32 s76, s76, s31
  s_lshl_b32 s31, s30, 1
  s_add_u32 s76, s76, s31
  s_lshl_b32 s76, s76, 12
  v_cndmask_b32 v34, v4, v5, vcc
  v_add_u32 v34, s76, v34
  s_cmp_ge_u32 s30, 9
  s_cselect_b32 s31, 9, 0
  s_cselect_b32 s76, 20224, 0
  s_sub_u32 s30, s30, s31
  s_mul_i32 s30, s30, s32
  s_add_u32 s76, s76, s30
  s_add_u32 s76, s76, s33
  s_add_u32 s30, s38, 20
  s_cmp_ge_u32 s30, 18
  s_cselect_b32 s31, 18, 0
  s_mov_b32 s32, 1152
  s_cmov_b32 s32, 1056
  s_cselect_b32 s33, 10496, 0
  s_mov_b32 s77, 576
  s_cmov_b32 s77, 1152
  s_cselect_b64 vcc, -1, 0
  s_sub_u32 s30, s30, s31
  s_mul_i32 s31, s18, 36
  s_add_u32 s77, s77, s31
  s_lshl_b32 s31, s30, 1
  s_add_u32 s77, s77, s31
  s_lshl_b32 s77, s77, 12
  v_cndmask_b32 v35, v4, v5, vcc
  v_add_u32 v35, s77, v35
  s_cmp_ge_u32 s30, 9
  s_cselect_b32 s31, 9, 0
  s_cselect_b32 s77, 20224, 0
  s_sub_u32 s30, s30, s31
  s_mul_i32 s30, s30, s32
  s_add_u32 s77, s77, s30
  s_add_u32 s77, s77, s33
  s_add_u32 s30, s38, 24
  s_cmp_ge_u32 s30, 18
  s_cselect_b32 s31, 18, 0
  s_mov_b32 s32, 1152
  s_cmov_b32 s32, 1056
  s_cselect_b32 s33, 10496, 0
  s_mov_b32 s78, 576
  s_cmov_b32 s78, 1152
  s_cselect_b64 vcc, -1, 0
  s_sub_u32 s30, s30, s31
  s_mul_i32 s31, s18, 36
  s_add_u32 s78, s78, s31
  s_lshl_b32 s31, s30, 1
  s_add_u32 s78, s78, s31
  s_lshl_b32 s78, s78, 12
  v_cndmask_b32 v36, v4, v5, vcc
  v_add_u32 v36, s78, v36
  s_cmp_ge_u32 s30, 9
  s_cselect_b32 s31, 9, 0
  s_cselect_b32 s78, 20224, 0
  s_sub_u32 s30, s30, s31
  s_mul_i32 s30, s30, s32
  s_add_u32 s78, s78, s30
  s_add_u32 s78, s78, s33
  s_add_u32 s30, s38, 28
  s_cmp_ge_u32 s30, 18
  s_cselect_b32 s31, 18, 0
  s_mov_b32 s32, 1152
  s_cmov_b32 s32, 1056
  s_cselect_b32 s33, 10496, 0
  s_mov_b32 s79, 576
  s_cmov_b32 s79, 1152
  s_cselect_b64 vcc, -1, 0
  s_sub_u32 s30, s30, s31
  s_mul_i32 s31, s18, 36
  s_add_u32 s79, s79, s31
  s_lshl_b32 s31, s30, 1
  s_add_u32 s79, s79, s31
  s_lshl_b32 s79, s79, 12
  v_cndmask_b32 v37, v4, v5, vcc
  v_add_u32 v37, s79, v37
  s_cmp_ge_u32 s30, 9
  s_cselect_b32 s31, 9, 0
  s_cselect_b32 s79, 20224, 0
  s_sub_u32 s30, s30, s31
  s_mul_i32 s30, s30, s32
  s_add_u32 s79, s79, s30
  s_add_u32 s79, s79, s33
  s_add_u32 s30, s38, 32
  s_cmp_ge_u32 s30, 18
  s_cselect_b32 s31, 18, 0
  s_mov_b32 s32, 1152
  s_cmov_b32 s32, 1056
  s_cselect_b32 s33, 10496, 0
  s_mov_b32 s80, 576
  s_cmov_b32 s80, 1152
  s_cselect_b64 vcc, -1, 0
  s_sub_u32 s30, s30, s31
  s_mul_i32 s31, s18, 36
  s_add_u32 s80, s80, s31
  s_lshl_b32 s31, s30, 1
  s_add_u32 s80, s80, s31
  s_lshl_b32 s80, s80, 12
  v_cndmask_b32 v38, v4, v5, vcc
  v_add_u32 v38, s80, v38
  s_cmp_ge_u32 s30, 9
  s_cselect_b32 s31, 9, 0
  s_cselect_b32 s80, 20224, 0
  s_sub_u32 s30, s30, s31
  s_mul_i32 s30, s30, s32
  s_add_u32 s80, s80, s30
  s_add_u32 s80, s80, s33
  v_subrev_u32 v3, 512, v0
  v_cmp_gt_u32 vcc, 192, v3
  v_lshlrev_b32 v3, 2, v3
  v_mov_b32 v2, 0x3f803f80
  v_mov_b32 v5, 0
  s_and_saveexec_b64 s[36:37], vcc
  s_cbranch_execz Lones_30
  v_add_u32 v4, 40448, v3
  ds_write_b32 v4, v2
  ds_write_b32 v4, v5 offset:768
  v_add_u32 v4, 82432, v3
  ds_write_b32 v4, v2
  ds_write_b32 v4, v5 offset:768
  v_add_u32 v4, 124416, v3
  ds_write_b32 v4, v2
  ds_write_b32 v4, v5 offset:768
Lones_30:
  s_mov_b64 exec, s[36:37]
  s_lshl_b32 s30, s17, 4
  s_add_u32 s30, s30, s18
  s_lshl_b32 s30, s30, 10
  s_add_u32 s30, s30, 33554432
  v_mov_b32 v39, s30
  v_lshlrev_b32 v40, 4, v1
  v_add_u32 v47, s72, v40
  v_add_u32 v51, s73, v40
  v_add_u32 v55, s74, v40
  v_add_u32 v59, s75, v40
  v_add_u32 v63, s76, v40
  v_add_u32 v67, s77, v40
  v_add_u32 v71, s78, v40
  v_add_u32 v75, s79, v40
  v_add_u32 v79, s80, v40
  s_lshl_b32 s26, s19, 9
  v_mov_b32 v4, 148480
  s_waitcnt lgkmcnt(0)
  s_barrier
  ds_read_b128 v[44:47], v47
  ds_read_b128 v[48:51], v51
  ds_read_b128 v[52:55], v55
  ds_read_b128 v[56:59], v59
  ds_read_b128 v[60:63], v63
  ds_read_b128 v[64:67], v67
  ds_read_b128 v[68:71], v71
  ds_read_b128 v[72:75], v75
  ds_read_b128 v[76:79], v79
  ds_read_b32 v4, v4
  s_waitcnt lgkmcnt(9)
  buffer_store_dwordx4 v[44:47], v30, s[8:11], s26 offen sc1
  s_waitcnt lgkmcnt(8)
  buffer_store_dwordx4 v[48:51], v31, s[8:11], s26 offen sc1
  s_waitcnt lgkmcnt(7)
  buffer_store_dwordx4 v[52:55], v32, s[8:11], s26 offen sc1
  s_waitcnt lgkmcnt(6)
  buffer_store_dwordx4 v[56:59], v33, s[8:11], s26 offen sc1
  s_waitcnt lgkmcnt(5)
  buffer_store_dwordx4 v[60:63], v34, s[8:11], s26 offen sc1
  s_waitcnt lgkmcnt(4)
  buffer_store_dwordx4 v[64:67], v35, s[8:11], s26 offen sc1
  s_waitcnt lgkmcnt(3)
  buffer_store_dwordx4 v[68:71], v36, s[8:11], s26 offen sc1
  s_waitcnt lgkmcnt(2)
  buffer_store_dwordx4 v[72:75], v37, s[8:11], s26 offen sc1
  s_waitcnt lgkmcnt(1)
  buffer_store_dwordx4 v[76:79], v38, s[8:11], s26 offen sc1
  s_waitcnt lgkmcnt(0)
  v_readfirstlane_b32 s81, v4
  s_waitcnt vmcnt(0)
  s_lshl_b32 s30, s19, 7
  v_add_u32 v2, s30, v39
  v_mov_b32 v3, s81
  v_mov_b32 v4, 148480
  v_mov_b32 v5, 1
  v_cmp_eq_u32 vcc, 0, v1
  s_and_saveexec_b64 s[36:37], vcc
  ds_add_rtn_u32 v5, v4, v5 offset:8
  s_waitcnt lgkmcnt(0)
  v_cmp_eq_u32 vcc, 3, v5
  s_and_b64 exec, exec, vcc
  s_cbranch_execz Lkf_31
  global_store_dword v2, v3, s[4:5] sc1
Lkf_31:
  s_mov_b64 exec, s[36:37]
  s_add_u32 s34, s19, 1
  s_and_b32 s34, s34, 7
  s_mov_b32 s25, 41984
  s_lshl_b32 s30, s34, 7
  v_add_u32 v2, s30, v39
  v_mov_b32 v3, 148496
  s_cmp_lg_u32 s38, 0
  s_cbranch_scc1 Lsp_32
  s_mov_b32 s31, 0
Lpp_34:
  global_load_dword v44, v2, s[4:5] sc1
  s_waitcnt vmcnt(0)
  v_cmp_eq_u32 vcc, s81, v44
  s_nop 3
  s_cmp_eq_u64 vcc, -1
  s_cbranch_scc1 Lppd_35
  s_add_u32 s31, s31, 1
  s_cmp_lt_u32 s31, 16384
  s_cbranch_scc1 Lpp_34
Lppd_35:
  v_mov_b32 v4, 1
  ds_write_b32 v3, v4
  s_waitcnt lgkmcnt(0)
  s_branch Lspd_33
Lsp_32:
  s_mov_b32 s31, 0
Lspl_36:
  ds_read_b32 v4, v3
  s_waitcnt lgkmcnt(0)
  v_cmp_le_u32 vcc, 1, v4
  s_nop 3
  s_cmp_eq_u64 vcc, -1
  s_cbranch_scc1 Lspd_33
  s_add_u32 s31, s31, 1
  s_cmp_lt_u32 s31, 262144
  s_cbranch_scc1 Lspl_36
Lspd_33:
  s_lshl_b32 s26, s34, 9
  s_add_u32 m0, s25, s72
  s_nop 0
  buffer_load_dwordx4 v30, s[8:11], s26 offen sc1 lds
  s_add_u32 m0, s25, s73
  s_nop 0
  buffer_load_dwordx4 v31, s[8:11], s26 offen sc1 lds
  s_add_u32 m0, s25, s74
  s_nop 0
  buffer_load_dwordx4 v32, s[8:11], s26 offen sc1 lds
  s_add_u32 m0, s25, s75
  s_nop 0
  buffer_load_dwordx4 v33, s[8:11], s26 offen sc1 lds
  s_add_u32 m0, s25, s76
  s_nop 0
  buffer_load_dwordx4 v34, s[8:11], s26 offen sc1 lds
  s_add_u32 m0, s25, s77
  s_nop 0
  buffer_load_dwordx4 v35, s[8:11], s26 offen sc1 lds
  s_add_u32 m0, s25, s78
  s_nop 0
  buffer_load_dwordx4 v36, s[8:11], s26 offen sc1 lds
  s_add_u32 m0, s25, s79
  s_nop 0
  buffer_load_dwordx4 v37, s[8:11], s26 offen sc1 lds
  s_add_u32 m0, s25, s80
  s_nop 0
  buffer_load_dwordx4 v38, s[8:11], s26 offen sc1 lds
  s_add_u32 s34, s34, 1
  s_and_b32 s34, s34, 7
  s_add_u32 s25, s25, 41984
  s_cmp_eq_u32 s25, 125952
  s_cselect_b32 s25, 0, s25
  s_add_u32 s56, s4, 16777216
  s_addc_u32 s57, s5, 0
  s_mov_b32 s58, 10485760
  s_mov_b32 s59, 0x20000
  s_mov_b32 s60, s12
  s_mov_b32 s61, s13
  s_mov_b32 s62, 663552
  s_mov_b32 s63, 0x20000
  s_mov_b32 s64, s14
  s_mov_b32 s65, s15
  s_mov_b32 s66, 4718592
  s_mov_b32 s67, 0x20000
  v_lshrrev_b32 v2, 3, v1
  s_lshr_b32 s30, s18, 3
  s_lshl_b32 s32, s30, 7
  s_lshl_b32 s31, s38, 5
  s_add_u32 s30, s32, s31
  v_add_u32 v2, s30, v2
  v_and_b32 v3, 7, v1
  v_lshrrev_b32 v4, 4, v1
  v_or_b32 v5, 0, v4
  v_xor_b32 v5, v5, v3
  v_add_u32 v6, 0, v2
  v_lshrrev_b32 v7, 2, v5
  v_mul_u32_u24 v7, 36864, v7
  v_lshl_add_u32 v7, v6, 5, v7
  v_bfe_u32 v80, v5, 1, 1
  v_lshl_add_u32 v7, v80, 13, v7
  v_and_b32 v80, 1, v5
  v_lshl_add_u32 v80, v80, 4, v7
  v_or_b32 v5, 4, v4
  v_xor_b32 v5, v5, v3
  v_add_u32 v6, 8, v2
  v_lshrrev_b32 v7, 2, v5
  v_mul_u32_u24 v7, 36864, v7
  v_lshl_add_u32 v7, v6, 5, v7
  v_bfe_u32 v81, v5, 1, 1
  v_lshl_add_u32 v7, v81, 13, v7
  v_and_b32 v81, 1, v5
  v_lshl_add_u32 v81, v81, 4, v7
  v_or_b32 v5, 0, v4
  v_xor_b32 v5, v5, v3
  v_add_u32 v6, 16, v2
  v_lshrrev_b32 v7, 2, v5
  v_mul_u32_u24 v7, 36864, v7
  v_lshl_add_u32 v7, v6, 5, v7
  v_bfe_u32 v82, v5, 1, 1
  v_lshl_add_u32 v7, v82, 13, v7
  v_and_b32 v82, 1, v5
  v_lshl_add_u32 v82, v82, 4, v7
  v_or_b32 v5, 4, v4
  v_xor_b32 v5, v5, v3
  v_add_u32 v6, 24, v2
  v_lshrrev_b32 v7, 2, v5
  v_mul_u32_u24 v7, 36864, v7
  v_lshl_add_u32 v7, v6, 5, v7
  v_bfe_u32 v83, v5, 1, 1
  v_lshl_add_u32 v7, v83, 13, v7
  v_and_b32 v83, 1, v5
  v_lshl_add_u32 v83, v83, 4, v7
  s_lshl_b32 s32, s32, 2
  s_add_u32 s32, s32, 16384
  v_and_b32 v84, 31, v1
  v_lshlrev_b32 v84, 4, v84
  v_lshrrev_b32 v7, 5, v1
  v_lshl_add_u32 v84, v7, 10, v84
  v_add_u32 v84, s32, v84
  s_lshl_b32 s30, s17, 3
  s_add_u32 s30, s30, s19
  s_lshl_b32 s30, s30, 11
  s_add_u32 s30, s30, 9437184
  v_lshrrev_b32 v2, 3, v1
  v_lshrrev_b32 v3, 2, v2
  v_lshl_add_u32 v4, v2, 1, v3
  v_xor_b32 v3, 1, v3
  v_lshl_add_u32 v5, v2, 1, v3
  v_lshlrev_b32 v4, 7, v4
  v_lshlrev_b32 v5, 7, v5
  v_add_u32 v85, s30, v4
  v_add_u32 v86, s30, v5
  s_and_b32 s32, s18, 7
  s_mul_i32 s32, s32, 144
  s_add_u32 s30, s38, 0
  s_lshl_b32 s30, s30, 6
  v_add_u32 v5, s30, v1
  v_mul_u32_u24 v6, 7282, v5
  v_lshrrev_b32 v6, 16, v6
  v_mul_u32_u24 v2, 9, v6
  v_sub_u32 v5, v5, v2
  v_lshlrev_b32 v5, 4, v5
  v_add_u32 v5, s32, v5
  v_lshrrev_b32 v2, 5, v6
  v_mul_u32_u24 v2, 72, v2
  v_bfe_u32 v3, v6, 3, 1
  v_mul_u32_u24 v3, 18, v3
  v_add_u32 v2, v2, v3
  v_bfe_u32 v3, v6, 2, 1
  v_lshl_add_u32 v2, v3, 3, v2
  v_bfe_u32 v3, v6, 4, 1
  v_lshl_add_u32 v2, v3, 2, v2
  v_and_b32 v3, 3, v6
  v_add_u32 v2, v2, v3
  v_mul_u32_u24 v2, 1152, v2
  v_add_u32 v87, v2, v5
  v_lshrrev_b32 v2, 5, v6
  v_lshlrev_b32 v2, 3, v2
  v_bfe_u32 v3, v6, 2, 2
  v_lshl_add_u32 v2, v3, 1, v2
  v_bfe_u32 v3, v6, 4, 1
  v_add_u32 v2, v2, v3
  v_mul_u32_u24 v2, 36, v2
  v_and_b32 v3, 3, v6
  v_add3_u32 v2, v2, v3, 16
  v_lshrrev_b32 v3, 1, v3
  v_lshl_add_u32 v2, v3, 4, v2
  v_mul_u32_u24 v2, 1152, v2
  v_add_u32 v90, v2, v5
  s_add_u32 s30, s38, 4
  s_lshl_b32 s30, s30, 6
  v_add_u32 v5, s30, v1
  v_mul_u32_u24 v6, 7282, v5
  v_lshrrev_b32 v6, 16, v6
  v_mul_u32_u24 v2, 9, v6
  v_sub_u32 v5, v5, v2
  v_lshlrev_b32 v5, 4, v5
  v_add_u32 v5, s32, v5
  v_lshrrev_b32 v2, 5, v6
  v_mul_u32_u24 v2, 72, v2
  v_bfe_u32 v3, v6, 3, 1
  v_mul_u32_u24 v3, 18, v3
  v_add_u32 v2, v2, v3
  v_bfe_u32 v3, v6, 2, 1
  v_lshl_add_u32 v2, v3, 3, v2
  v_bfe_u32 v3, v6, 4, 1
  v_lshl_add_u32 v2, v3, 2, v2
  v_and_b32 v3, 3, v6
  v_add_u32 v2, v2, v3
  v_mul_u32_u24 v2, 1152, v2
  v_add_u32 v88, v2, v5
  v_lshrrev_b32 v2, 5, v6
  v_lshlrev_b32 v2, 3, v2
  v_bfe_u32 v3, v6, 2, 2
  v_lshl_add_u32 v2, v3, 1, v2
  v_bfe_u32 v3, v6, 4, 1
  v_add_u32 v2, v2, v3
  v_mul_u32_u24 v2, 36, v2
  v_and_b32 v3, 3, v6
  v_add3_u32 v2, v2, v3, 16
  v_lshrrev_b32 v3, 1, v3
  v_lshl_add_u32 v2, v3, 4, v2
  v_mul_u32_u24 v2, 1152, v2
  v_add_u32 v91, v2, v5
  s_movk_i32 s30, 512
  v_add_u32 v5, s30, v1
  v_mul_u32_u24 v6, 7282, v5
  v_lshrrev_b32 v6, 16, v6
  v_mul_u32_u24 v2, 9, v6
  v_sub_u32 v5, v5, v2
  v_lshlrev_b32 v5, 4, v5
  v_add_u32 v5, s32, v5
  v_lshrrev_b32 v2, 5, v6
  v_mul_u32_u24 v2, 72, v2
  v_bfe_u32 v3, v6, 3, 1
  v_mul_u32_u24 v3, 18, v3
  v_add_u32 v2, v2, v3
  v_bfe_u32 v3, v6, 2, 1
  v_lshl_add_u32 v2, v3, 3, v2
  v_bfe_u32 v3, v6, 4, 1
  v_lshl_add_u32 v2, v3, 2, v2
  v_and_b32 v3, 3, v6
  v_add_u32 v2, v2, v3
  v_mul_u32_u24 v2, 1152, v2
  v_add_u32 v89, v2, v5
  v_lshrrev_b32 v2, 5, v6
  v_lshlrev_b32 v2, 3, v2
  v_bfe_u32 v3, v6, 2, 2
  v_lshl_add_u32 v2, v3, 1, v2
  v_bfe_u32 v3, v6, 4, 1
  v_add_u32 v2, v2, v3
  v_mul_u32_u24 v2, 36, v2
  v_and_b32 v3, 3, v6
  v_add3_u32 v2, v2, v3, 16
  v_lshrrev_b32 v3, 1, v3
  v_lshl_add_u32 v2, v3, 4, v2
  v_mul_u32_u24 v2, 1152, v2
  v_add_u32 v92, v2, v5
  s_lshl_b32 s51, s17, 3
  s_add_u32 s51, s51, s19
  s_mul_i32 s51, s51, 294912
  s_mul_i32 s52, s18, 18432
  s_add_u32 s52, s52, s51
  s_lshl_b32 s53, s17, 3
  s_add_u32 s53, s53, s19
  s_lshl_b32 s53, s53, 4
  s_add_u32 s53, s53, s18
  s_lshl_b32 s53, s53, 7
  s_lshl_b32 s31, s38, 2
  s_add_u32 s53, s53, s31
  s_add_u32 s53, s53, 9437184
  s_waitcnt vmcnt(0)
  s_barrier
  s_lshl_b32 s30, s34, 7
  v_add_u32 v2, s30, v39
  v_mov_b32 v3, 148496
  s_cmp_lg_u32 s38, 0
  s_cbranch_scc1 Lsp_37
  s_mov_b32 s31, 0
Lpp_39:
  global_load_dword v44, v2, s[4:5] sc1
  s_waitcnt vmcnt(0)
  v_cmp_eq_u32 vcc, s81, v44
  s_nop 3
  s_cmp_eq_u64 vcc, -1
  s_cbranch_scc1 Lppd_40
  s_add_u32 s31, s31, 1
  s_cmp_lt_u32 s31, 16384
  s_cbranch_scc1 Lpp_39
Lppd_40:
  v_mov_b32 v4, 2
  ds_write_b32 v3, v4
  s_waitcnt lgkmcnt(0)
  s_branch Lspd_38
Lsp_37:
  s_mov_b32 s31, 0
Lspl_41:
  ds_read_b32 v4, v3
  s_waitcnt lgkmcnt(0)
  v_cmp_le_u32 vcc, 2, v4
  s_nop 3
  s_cmp_eq_u64 vcc, -1
  s_cbranch_scc1 Lspd_38
  s_add_u32 s31, s31, 1
  s_cmp_lt_u32 s31, 262144
  s_cbranch_scc1 Lspl_41
Lspd_38:
  s_lshl_b32 s26, s34, 9
  s_add_u32 m0, s25, s72
  s_nop 0
  buffer_load_dwordx4 v30, s[8:11], s26 offen sc1 lds
  s_add_u32 m0, s25, s73
  s_nop 0
  buffer_load_dwordx4 v31, s[8:11], s26 offen sc1 lds
  s_add_u32 m0, s25, s74
  s_nop 0
  buffer_load_dwordx4 v32, s[8:11], s26 offen sc1 lds
  s_add_u32 m0, s25, s75
  s_nop 0
  buffer_load_dwordx4 v33, s[8:11], s26 offen sc1 lds
  s_add_u32 m0, s25, s76
  s_nop 0
  buffer_load_dwordx4 v34, s[8:11], s26 offen sc1 lds
  s_add_u32 m0, s25, s77
  s_nop 0
  buffer_load_dwordx4 v35, s[8:11], s26 offen sc1 lds
  s_add_u32 m0, s25, s78
  s_nop 0
  buffer_load_dwordx4 v36, s[8:11], s26 offen sc1 lds
  s_add_u32 m0, s25, s79
  s_nop 0
  buffer_load_dwordx4 v37, s[8:11], s26 offen sc1 lds
  s_add_u32 m0, s25, s80
  s_nop 0
  buffer_load_dwordx4 v38, s[8:11], s26 offen sc1 lds
  s_add_u32 s34, s34, 1
  s_and_b32 s34, s34, 7
  s_add_u32 s25, s25, 41984
  s_cmp_eq_u32 s25, 125952
  s_cselect_b32 s25, 0, s25
  s_waitcnt vmcnt(0)
  s_barrier
  s_lshl_b32 s30, s34, 7
  v_add_u32 v2, s30, v39
  v_mov_b32 v3, 148496
  s_cmp_lg_u32 s38, 0
  s_cbranch_scc1 Lsp_42
  s_mov_b32 s31, 0
Lpp_44:
  global_load_dword v44, v2, s[4:5] sc1
  s_waitcnt vmcnt(0)
  v_cmp_eq_u32 vcc, s81, v44
  s_nop 3
  s_cmp_eq_u64 vcc, -1
  s_cbranch_scc1 Lppd_45
  s_add_u32 s31, s31, 1
  s_cmp_lt_u32 s31, 16384
  s_cbranch_scc1 Lpp_44
Lppd_45:
  v_mov_b32 v4, 3
  ds_write_b32 v3, v4
  s_waitcnt lgkmcnt(0)
  s_branch Lspd_43
Lsp_42:
  s_mov_b32 s31, 0
Lspl_46:
  ds_read_b32 v4, v3
  s_waitcnt lgkmcnt(0)
  v_cmp_le_u32 vcc, 3, v4
  s_nop 3
  s_cmp_eq_u64 vcc, -1
  s_cbranch_scc1 Lspd_43
  s_add_u32 s31, s31, 1
  s_cmp_lt_u32 s31, 262144
  s_cbranch_scc1 Lspl_46
Lspd_43:
  s_lshl_b32 s26, s34, 9
  s_add_u32 m0, s25, s72
  s_nop 0
  buffer_load_dwordx4 v30, s[8:11], s26 offen sc1 lds
  s_add_u32 m0, s25, s73
  s_nop 0
  buffer_load_dwordx4 v31, s[8:11], s26 offen sc1 lds
  s_add_u32 m0, s25, s74
  s_nop 0
  buffer_load_dwordx4 v32, s[8:11], s26 offen sc1 lds
  s_add_u32 m0, s25, s75
  s_nop 0
  buffer_load_dwordx4 v33, s[8:11], s26 offen sc1 lds
  s_add_u32 m0, s25, s76
  s_nop 0
  buffer_load_dwordx4 v34, s[8:11], s26 offen sc1 lds
  s_add_u32 m0, s25, s77
  s_nop 0
  buffer_load_dwordx4 v35, s[8:11], s26 offen sc1 lds
  s_add_u32 m0, s25, s78
  s_nop 0
  buffer_load_dwordx4 v36, s[8:11], s26 offen sc1 lds
  s_add_u32 m0, s25, s79
  s_nop 0
  buffer_load_dwordx4 v37, s[8:11], s26 offen sc1 lds
  s_add_u32 m0, s25, s80
  s_nop 0
  buffer_load_dwordx4 v38, s[8:11], s26 offen sc1 lds
  s_add_u32 s34, s34, 1
  s_and_b32 s34, s34, 7
  s_add_u32 s25, s25, 41984
  s_cmp_eq_u32 s25, 125952
  s_cselect_b32 s25, 0, s25
  s_waitcnt vmcnt(0)
  s_barrier
  s_lshl_b32 s30, s34, 7
  v_add_u32 v2, s30, v39
  v_mov_b32 v3, 148496
  s_cmp_lg_u32 s38, 0
  s_cbranch_scc1 Lsp_47
  s_mov_b32 s31, 0
Lpp_49:
  global_load_dword v44, v2, s[4:5] sc1
  s_waitcnt vmcnt(0)
  v_cmp_eq_u32 vcc, s81, v44
  s_nop 3
  s_cmp_eq_u64 vcc, -1
  s_cbranch_scc1 Lppd_50
  s_add_u32 s31, s31, 1
  s_cmp_lt_u32 s31, 16384
  s_cbranch_scc1 Lpp_49
Lppd_50:
  v_mov_b32 v4, 4
  ds_write_b32 v3, v4
  s_waitcnt lgkmcnt(0)
  s_branch Lspd_48
Lsp_47:
  s_mov_b32 s31, 0
Lspl_51:
  ds_read_b32 v4, v3
  s_waitcnt lgkmcnt(0)
  v_cmp_le_u32 vcc, 4, v4
  s_nop 3
  s_cmp_eq_u64 vcc, -1
  s_cbranch_scc1 Lspd_48
  s_add_u32 s31, s31, 1
  s_cmp_lt_u32 s31, 262144
  s_cbranch_scc1 Lspl_51
Lspd_48:
  s_lshl_b32 s26, s34, 9
  s_add_u32 m0, s25, s72
  s_nop 0
  buffer_load_dwordx4 v30, s[8:11], s26 offen sc1 lds
  s_add_u32 m0, s25, s73
  s_nop 0
  buffer_load_dwordx4 v31, s[8:11], s26 offen sc1 lds
  s_add_u32 m0, s25, s74
  s_nop 0
  buffer_load_dwordx4 v32, s[8:11], s26 offen sc1 lds
  s_add_u32 m0, s25, s75
  s_nop 0
  buffer_load_dwordx4 v33, s[8:11], s26 offen sc1 lds
  s_add_u32 m0, s25, s76
  s_nop 0
  buffer_load_dwordx4 v34, s[8:11], s26 offen sc1 lds
  s_add_u32 m0, s25, s77
  s_nop 0
  buffer_load_dwordx4 v35, s[8:11], s26 offen sc1 lds
  s_add_u32 m0, s25, s78
  s_nop 0
  buffer_load_dwordx4 v36, s[8:11], s26 offen sc1 lds
  s_add_u32 m0, s25, s79
  s_nop 0
  buffer_load_dwordx4 v37, s[8:11], s26 offen sc1 lds
  s_add_u32 m0, s25, s80
  s_nop 0
  buffer_load_dwordx4 v38, s[8:11], s26 offen sc1 lds
  s_add_u32 s34, s34, 1
  s_and_b32 s34, s34, 7
  s_add_u32 s25, s25, 41984
  s_cmp_eq_u32 s25, 125952
  s_cselect_b32 s25, 0, s25
  s_waitcnt vmcnt(0)
  s_barrier
  s_lshl_b32 s30, s34, 7
  v_add_u32 v2, s30, v39
  v_mov_b32 v3, 148496
  s_cmp_lg_u32 s38, 0
  s_cbranch_scc1 Lsp_52
  s_mov_b32 s31, 0
Lpp_54:
  global_load_dword v44, v2, s[4:5] sc1
  s_waitcnt vmcnt(0)
  v_cmp_eq_u32 vcc, s81, v44
  s_nop 3
  s_cmp_eq_u64 vcc, -1
  s_cbranch_scc1 Lppd_55
  s_add_u32 s31, s31, 1
  s_cmp_lt_u32 s31, 16384
  s_cbranch_scc1 Lpp_54
Lppd_55:
  v_mov_b32 v4, 5
  ds_write_b32 v3, v4
  s_waitcnt lgkmcnt(0)
  s_branch Lspd_53
Lsp_52:
  s_mov_b32 s31, 0
Lspl_56:
  ds_read_b32 v4, v3
  s_waitcnt lgkmcnt(0)
  v_cmp_le_u32 vcc, 5, v4
  s_nop 3
  s_cmp_eq_u64 vcc, -1
  s_cbranch_scc1 Lspd_53
  s_add_u32 s31, s31, 1
  s_cmp_lt_u32 s31, 262144
  s_cbranch_scc1 Lspl_56
Lspd_53:
  s_lshl_b32 s26, s34, 9
  s_add_u32 m0, s25, s72
  s_nop 0
  buffer_load_dwordx4 v30, s[8:11], s26 offen sc1 lds
  s_add_u32 m0, s25, s73
  s_nop 0
  buffer_load_dwordx4 v31, s[8:11], s26 offen sc1 lds
  s_add_u32 m0, s25, s74
  s_nop 0
  buffer_load_dwordx4 v32, s[8:11], s26 offen sc1 lds
  s_add_u32 m0, s25, s75
  s_nop 0
  buffer_load_dwordx4 v33, s[8:11], s26 offen sc1 lds
  s_add_u32 m0, s25, s76
  s_nop 0
  buffer_load_dwordx4 v34, s[8:11], s26 offen sc1 lds
  s_add_u32 m0, s25, s77
  s_nop 0
  buffer_load_dwordx4 v35, s[8:11], s26 offen sc1 lds
  s_add_u32 m0, s25, s78
  s_nop 0
  buffer_load_dwordx4 v36, s[8:11], s26 offen sc1 lds
  s_add_u32 m0, s25, s79
  s_nop 0
  buffer_load_dwordx4 v37, s[8:11], s26 offen sc1 lds
  s_add_u32 m0, s25, s80
  s_nop 0
  buffer_load_dwordx4 v38, s[8:11], s26 offen sc1 lds
  s_add_u32 s34, s34, 1
  s_and_b32 s34, s34, 7
  s_add_u32 s25, s25, 41984
  s_cmp_eq_u32 s25, 125952
  s_cselect_b32 s25, 0, s25
  s_waitcnt vmcnt(0)
  s_barrier
  s_lshl_b32 s30, s34, 7
  v_add_u32 v2, s30, v39
  v_mov_b32 v3, 148496
  s_cmp_lg_u32 s38, 0
  s_cbranch_scc1 Lsp_57
  s_mov_b32 s31, 0
Lpp_59:
  global_load_dword v44, v2, s[4:5] sc1
  s_waitcnt vmcnt(0)
  v_cmp_eq_u32 vcc, s81, v44
  s_nop 3
  s_cmp_eq_u64 vcc, -1
  s_cbranch_scc1 Lppd_60
  s_add_u32 s31, s31, 1
  s_cmp_lt_u32 s31, 16384
  s_cbranch_scc1 Lpp_59
Lppd_60:
  v_mov_b32 v4, 6
  ds_write_b32 v3, v4
  s_waitcnt lgkmcnt(0)
  s_branch Lspd_58
Lsp_57:
  s_mov_b32 s31, 0
Lspl_61:
  ds_read_b32 v4, v3
  s_waitcnt lgkmcnt(0)
  v_cmp_le_u32 vcc, 6, v4
  s_nop 3
  s_cmp_eq_u64 vcc, -1
  s_cbranch_scc1 Lspd_58
  s_add_u32 s31, s31, 1
  s_cmp_lt_u32 s31, 262144
  s_cbranch_scc1 Lspl_61
Lspd_58:
  s_lshl_b32 s26, s34, 9
  s_add_u32 m0, s25, s72
  s_nop 0
  buffer_load_dwordx4 v30, s[8:11], s26 offen sc1 lds
  s_add_u32 m0, s25, s73
  s_nop 0
  buffer_load_dwordx4 v31, s[8:11], s26 offen sc1 lds
  s_add_u32 m0, s25, s74
  s_nop 0
  buffer_load_dwordx4 v32, s[8:11], s26 offen sc1 lds
  s_add_u32 m0, s25, s75
  s_nop 0
  buffer_load_dwordx4 v33, s[8:11], s26 offen sc1 lds
  s_add_u32 m0, s25, s76
  s_nop 0
  buffer_load_dwordx4 v34, s[8:11], s26 offen sc1 lds
  s_add_u32 m0, s25, s77
  s_nop 0
  buffer_load_dwordx4 v35, s[8:11], s26 offen sc1 lds
  s_add_u32 m0, s25, s78
  s_nop 0
  buffer_load_dwordx4 v36, s[8:11], s26 offen sc1 lds
  s_add_u32 m0, s25, s79
  s_nop 0
  buffer_load_dwordx4 v37, s[8:11], s26 offen sc1 lds
  s_add_u32 m0, s25, s80
  s_nop 0
  buffer_load_dwordx4 v38, s[8:11], s26 offen sc1 lds
  s_add_u32 s34, s34, 1
  s_and_b32 s34, s34, 7
  s_add_u32 s25, s25, 41984
  s_cmp_eq_u32 s25, 125952
  s_cselect_b32 s25, 0, s25
  s_waitcnt vmcnt(0)
  s_barrier
  s_lshl_b32 s46, s18, 1
  s_and_b32 s47, s19, 1
  s_add_u32 s46, s46, s47
  s_mul_i32 s46, s46, 162
  s_lshl_b32 s47, s38, 6
  v_add_u32 v3, s47, v1
  v_min_u32 v3, 161, v3
  v_add_u32 v3, s46, v3
  v_lshlrev_b32 v3, 7, v3
  global_load_dword v4, v3, s[12:13]
  s_lshl_b32 s30, s34, 7
  v_add_u32 v2, s30, v39
  v_mov_b32 v3, 148496
  s_cmp_lg_u32 s38, 0
  s_cbranch_scc1 Lsp_62
  s_mov_b32 s31, 0
Lpp_64:
  global_load_dword v44, v2, s[4:5] sc1
  s_waitcnt vmcnt(0)
  v_cmp_eq_u32 vcc, s81, v44
  s_nop 3
  s_cmp_eq_u64 vcc, -1
  s_cbranch_scc1 Lppd_65
  s_add_u32 s31, s31, 1
  s_cmp_lt_u32 s31, 16384
  s_cbranch_scc1 Lpp_64
Lppd_65:
  v_mov_b32 v4, 7
  ds_write_b32 v3, v4
  s_waitcnt lgkmcnt(0)
  s_branch Lspd_63
Lsp_62:
  s_mov_b32 s31, 0
Lspl_66:
  ds_read_b32 v4, v3
  s_waitcnt lgkmcnt(0)
  v_cmp_le_u32 vcc, 7, v4
  s_nop 3
  s_cmp_eq_u64 vcc, -1
  s_cbranch_scc1 Lspd_63
  s_add_u32 s31, s31, 1
  s_cmp_lt_u32 s31, 262144
  s_cbranch_scc1 Lspl_66
Lspd_63:
  s_lshl_b32 s26, s34, 9
  s_add_u32 m0, s25, s72
  s_nop 0
  buffer_load_dwordx4 v30, s[8:11], s26 offen sc1 lds
  s_add_u32 m0, s25, s73
  s_nop 0
  buffer_load_dwordx4 v31, s[8:11], s26 offen sc1 lds
  s_add_u32 m0, s25, s74
  s_nop 0
  buffer_load_dwordx4 v32, s[8:11], s26 offen sc1 lds
  s_add_u32 m0, s25, s75
  s_nop 0
  buffer_load_dwordx4 v33, s[8:11], s26 offen sc1 lds
  s_add_u32 m0, s25, s76
  s_nop 0
  buffer_load_dwordx4 v34, s[8:11], s26 offen sc1 lds
  s_add_u32 m0, s25, s77
  s_nop 0
  buffer_load_dwordx4 v35, s[8:11], s26 offen sc1 lds
  s_add_u32 m0, s25, s78
  s_nop 0
  buffer_load_dwordx4 v36, s[8:11], s26 offen sc1 lds
  s_add_u32 m0, s25, s79
  s_nop 0
  buffer_load_dwordx4 v37, s[8:11], s26 offen sc1 lds
  s_add_u32 m0, s25, s80
  s_nop 0
  buffer_load_dwordx4 v38, s[8:11], s26 offen sc1 lds
  s_add_u32 s34, s34, 1
  s_and_b32 s34, s34, 7
  s_add_u32 s25, s25, 41984
  s_cmp_eq_u32 s25, 125952
  s_cselect_b32 s25, 0, s25
  s_waitcnt vmcnt(0)
  s_barrier
  s_lshl_b32 s30, s38, 10
  s_add_u32 m0, s30, 83968
  s_mov_b32 s31, 0
  buffer_load_dwordx4 v87, s[60:63], s31 offen lds
  s_lshl_b32 s30, s38, 10
  s_add_u32 m0, s30, 88064
  s_mov_b32 s31, 0
  buffer_load_dwordx4 v88, s[60:63], s31 offen lds
  s_cmp_lg_u32 s38, 0
  s_cbranch_scc1 Lw8_67
  s_mov_b32 m0, 92160
  s_mov_b32 s31, 0
  buffer_load_dwordx4 v89, s[60:63], s31 offen lds
Lw8_67:
  s_lshl_b32 s30, s38, 10
  s_add_u32 m0, s30, 93184
  s_mov_b32 s31, 165888
  buffer_load_dwordx4 v87, s[60:63], s31 offen lds
  s_lshl_b32 s30, s38, 10
  s_add_u32 m0, s30, 97280
  s_mov_b32 s31, 165888
  buffer_load_dwordx4 v88, s[60:63], s31 offen lds
  s_cmp_lg_u32 s38, 0
  s_cbranch_scc1 Lw8_68
  s_mov_b32 m0, 101376
  s_mov_b32 s31, 165888
  buffer_load_dwordx4 v89, s[60:63], s31 offen lds
Lw8_68:
  s_lshl_b32 s30, s38, 10
  s_add_u32 m0, s30, 102400
  s_mov_b32 s31, 373248
  buffer_load_dwordx4 v87, s[60:63], s31 offen lds
  s_lshl_b32 s30, s38, 10
  s_add_u32 m0, s30, 106496
  s_mov_b32 s31, 373248
  buffer_load_dwordx4 v88, s[60:63], s31 offen lds
  s_cmp_lg_u32 s38, 0
  s_cbranch_scc1 Lw8_69
  s_mov_b32 m0, 110592
  s_mov_b32 s31, 373248
  buffer_load_dwordx4 v89, s[60:63], s31 offen lds
Lw8_69:
  s_lshl_b32 s30, s38, 10
  s_add_u32 m0, s30, 111616
  s_mov_b32 s31, 539136
  buffer_load_dwordx4 v87, s[60:63], s31 offen lds
  s_lshl_b32 s30, s38, 10
  s_add_u32 m0, s30, 115712
  s_mov_b32 s31, 539136
  buffer_load_dwordx4 v88, s[60:63], s31 offen lds
  s_cmp_lg_u32 s38, 0
  s_cbranch_scc1 Lw8_70
  s_mov_b32 m0, 119808
  s_mov_b32 s31, 539136
  buffer_load_dwordx4 v89, s[60:63], s31 offen lds
Lw8_70:
  s_lshl_b32 s30, s38, 10
  s_add_u32 m0, s30, 120832
  s_mov_b32 s31, 41472
  buffer_load_dwordx4 v87, s[60:63], s31 offen lds
  s_lshl_b32 s30, s38, 10
  s_add_u32 m0, s30, 124928
  s_mov_b32 s31, 41472
  buffer_load_dwordx4 v88, s[60:63], s31 offen lds
  s_cmp_lg_u32 s38, 0
  s_cbranch_scc1 Lw8_71
  s_mov_b32 m0, 129024
  s_mov_b32 s31, 41472
  buffer_load_dwordx4 v89, s[60:63], s31 offen lds
Lw8_71:
  s_lshl_b32 s30, s38, 10
  s_add_u32 m0, s30, 130048
  s_mov_b32 s31, 207360
  buffer_load_dwordx4 v87, s[60:63], s31 offen lds
  s_lshl_b32 s30, s38, 10
  s_add_u32 m0, s30, 134144
  s_mov_b32 s31, 207360
  buffer_load_dwordx4 v88, s[60:63], s31 offen lds
  s_cmp_lg_u32 s38, 0
  s_cbranch_scc1 Lw8_72
  s_mov_b32 m0, 138240
  s_mov_b32 s31, 207360
  buffer_load_dwordx4 v89, s[60:63], s31 offen lds
Lw8_72:
  s_lshl_b32 s30, s38, 10
  s_add_u32 m0, s30, 139264
  s_mov_b32 s31, 331776
  buffer_load_dwordx4 v87, s[60:63], s31 offen lds
  s_lshl_b32 s30, s38, 10
  s_add_u32 m0, s30, 143360
  s_mov_b32 s31, 331776
  buffer_load_dwordx4 v88, s[60:63], s31 offen lds
  s_cmp_lg_u32 s38, 0
  s_cbranch_scc1 Lw8_73
  s_mov_b32 m0, 147456
  s_mov_b32 s31, 331776
  buffer_load_dwordx4 v89, s[60:63], s31 offen lds
Lw8_73:
  s_waitcnt vmcnt(0)
  s_barrier
  s_lshl_b32 s30, s38, 10
  s_add_u32 m0, s30, 0
  s_mov_b32 s31, 497664
  buffer_load_dwordx4 v87, s[60:63], s31 offen lds
  s_lshl_b32 s30, s38, 10
  s_add_u32 m0, s30, 4096
  s_mov_b32 s31, 497664
  buffer_load_dwordx4 v88, s[60:63], s31 offen lds
  s_cmp_lg_u32 s38, 0
  s_cbranch_scc1 Lw8_74
  s_mov_b32 m0, 8192
  s_mov_b32 s31, 497664
  buffer_load_dwordx4 v89, s[60:63], s31 offen lds
Lw8_74:
  s_lshl_b32 s30, s38, 10
  s_add_u32 m0, s30, 9216
  s_mov_b32 s31, 0
  buffer_load_dwordx4 v90, s[60:63], s31 offen lds
  s_lshl_b32 s30, s38, 10
  s_add_u32 m0, s30, 13312
  s_mov_b32 s31, 0
  buffer_load_dwordx4 v91, s[60:63], s31 offen lds
  s_cmp_lg_u32 s38, 0
  s_cbranch_scc1 Lw8_75
  s_mov_b32 m0, 17408
  s_mov_b32 s31, 0
  buffer_load_dwordx4 v92, s[60:63], s31 offen lds
Lw8_75:
  s_barrier
  v_mov_b32 v2, 148484
  ds_read_b32 v2, v2
  s_waitcnt lgkmcnt(0)
  v_readfirstlane_b32 s40, v2
  s_nop 3
  s_cmp_lg_u32 s40, 0
  s_cbranch_scc0 concat_heads__mha_block__mha_block__prompt_kernel_noslow
  s_mov_b32 s46, 0
concat_heads__mha_block__mha_block__prompt_kernel_lsl:
  s_and_b32 s34, s46, 7
  s_mov_b32 s25, 0
  s_lshl_b32 s26, s34, 9
  s_add_u32 m0, s25, s72
  s_nop 0
  buffer_load_dwordx4 v30, s[8:11], s26 offen sc1 lds
  s_add_u32 m0, s25, s73
  s_nop 0
  buffer_load_dwordx4 v31, s[8:11], s26 offen sc1 lds
  s_add_u32 m0, s25, s74
  s_nop 0
  buffer_load_dwordx4 v32, s[8:11], s26 offen sc1 lds
  s_add_u32 m0, s25, s75
  s_nop 0
  buffer_load_dwordx4 v33, s[8:11], s26 offen sc1 lds
  s_add_u32 m0, s25, s76
  s_nop 0
  buffer_load_dwordx4 v34, s[8:11], s26 offen sc1 lds
  s_add_u32 m0, s25, s77
  s_nop 0
  buffer_load_dwordx4 v35, s[8:11], s26 offen sc1 lds
  s_add_u32 m0, s25, s78
  s_nop 0
  buffer_load_dwordx4 v36, s[8:11], s26 offen sc1 lds
  s_add_u32 m0, s25, s79
  s_nop 0
  buffer_load_dwordx4 v37, s[8:11], s26 offen sc1 lds
  s_add_u32 m0, s25, s80
  s_nop 0
  buffer_load_dwordx4 v38, s[8:11], s26 offen sc1 lds
  s_add_u32 s34, s34, 1
  s_and_b32 s34, s34, 7
  s_add_u32 s25, s25, 41984
  s_cmp_eq_u32 s25, 125952
  s_cselect_b32 s25, 0, s25
  s_waitcnt vmcnt(0)
  s_barrier
  s_barrier
  s_add_u32 s46, s46, 1
  s_cmp_lt_u32 s46, 16
  s_cbranch_scc1 concat_heads__mha_block__mha_block__prompt_kernel_lsl
  s_lshl_b32 s30, s38, 10
  s_add_u32 m0, s30, 0
  s_mov_b32 s31, 497664
  buffer_load_dwordx4 v87, s[60:63], s31 offen lds
  s_lshl_b32 s30, s38, 10
  s_add_u32 m0, s30, 4096
  s_mov_b32 s31, 497664
  buffer_load_dwordx4 v88, s[60:63], s31 offen lds
  s_cmp_lg_u32 s38, 0
  s_cbranch_scc1 Lw8_76
  s_mov_b32 m0, 8192
  s_mov_b32 s31, 497664
  buffer_load_dwordx4 v89, s[60:63], s31 offen lds
Lw8_76:
  s_lshl_b32 s30, s38, 10
  s_add_u32 m0, s30, 9216
  s_mov_b32 s31, 0
  buffer_load_dwordx4 v90, s[60:63], s31 offen lds
  s_lshl_b32 s30, s38, 10
  s_add_u32 m0, s30, 13312
  s_mov_b32 s31, 0
  buffer_load_dwordx4 v91, s[60:63], s31 offen lds
  s_cmp_lg_u32 s38, 0
  s_cbranch_scc1 Lw8_77
  s_mov_b32 m0, 17408
  s_mov_b32 s31, 0
  buffer_load_dwordx4 v92, s[60:63], s31 offen lds
Lw8_77:
concat_heads__mha_block__mha_block__prompt_kernel_noslow:
  v_mov_b32 v3, 148496
  s_cmp_lg_u32 s38, 0
  s_cbranch_scc1 Lsp_78
  s_mov_b32 s32, 0
Lpp_80:
  buffer_load_dword v96, v85, s[56:59], 0 offen sc1
  s_waitcnt vmcnt(0)
  v_cmp_eq_u32 vcc, s81, v96
  s_nop 3
  s_cmp_eq_u64 vcc, -1
  s_cbranch_scc1 Lppd_81
  s_add_u32 s32, s32, 1
  s_cmp_lt_u32 s32, 16384
  s_cbranch_scc1 Lpp_80
Lppd_81:
  v_mov_b32 v4, 8
  ds_write_b32 v3, v4
  s_waitcnt lgkmcnt(0)
  s_branch Lspd_79
Lsp_78:
  s_mov_b32 s32, 0
Lspl_82:
  ds_read_b32 v4, v3
  s_waitcnt lgkmcnt(0)
  v_cmp_le_u32 vcc, 8, v4
  s_nop 3
  s_cmp_eq_u64 vcc, -1
  s_cbranch_scc1 Lspd_79
  s_add_u32 s32, s32, 1
  s_cmp_lt_u32 s32, 262144
  s_cbranch_scc1 Lspl_82
Lspd_79:
  s_lshl_b32 s30, s38, 12
  s_add_u32 m0, s30, 18432
  s_add_u32 s31, s51, 0
  buffer_load_dwordx4 v80, s[56:59], s31 offen sc1 lds
  s_lshl_b32 s30, s38, 12
  s_add_u32 m0, s30, 19456
  s_add_u32 s31, s51, 0
  buffer_load_dwordx4 v81, s[56:59], s31 offen sc1 lds
  s_lshl_b32 s30, s38, 12
  s_add_u32 m0, s30, 20480
  s_add_u32 s31, s51, 0
  buffer_load_dwordx4 v82, s[56:59], s31 offen sc1 lds
  s_lshl_b32 s30, s38, 12
  s_add_u32 m0, s30, 21504
  s_add_u32 s31, s51, 0
  buffer_load_dwordx4 v83, s[56:59], s31 offen sc1 lds
  s_lshl_b32 s30, s38, 12
  s_add_u32 m0, s30, 34816
  s_add_u32 s31, s51, 73728
  buffer_load_dwordx4 v80, s[56:59], s31 offen sc1 lds
  s_lshl_b32 s30, s38, 12
  s_add_u32 m0, s30, 35840
  s_add_u32 s31, s51, 73728
  buffer_load_dwordx4 v81, s[56:59], s31 offen sc1 lds
  s_lshl_b32 s30, s38, 12
  s_add_u32 m0, s30, 36864
  s_add_u32 s31, s51, 73728
  buffer_load_dwordx4 v82, s[56:59], s31 offen sc1 lds
  s_lshl_b32 s30, s38, 12
  s_add_u32 m0, s30, 37888
  s_add_u32 s31, s51, 73728
  buffer_load_dwordx4 v83, s[56:59], s31 offen sc1 lds
  s_lshl_b32 s30, s38, 12
  s_add_u32 m0, s30, 51200
  s_add_u32 s31, s51, 165888
  buffer_load_dwordx4 v80, s[56:59], s31 offen sc1 lds
  s_lshl_b32 s30, s38, 12
  s_add_u32 m0, s30, 52224
  s_add_u32 s31, s51, 165888
  buffer_load_dwordx4 v81, s[56:59], s31 offen sc1 lds
  s_lshl_b32 s30, s38, 12
  s_add_u32 m0, s30, 53248
  s_add_u32 s31, s51, 165888
  buffer_load_dwordx4 v82, s[56:59], s31 offen sc1 lds
  s_lshl_b32 s30, s38, 12
  s_add_u32 m0, s30, 54272
  s_add_u32 s31, s51, 165888
  buffer_load_dwordx4 v83, s[56:59], s31 offen sc1 lds
  s_lshl_b32 s30, s38, 12
  s_add_u32 m0, s30, 67584
  s_add_u32 s31, s51, 239616
  buffer_load_dwordx4 v80, s[56:59], s31 offen sc1 lds
  s_lshl_b32 s30, s38, 12
  s_add_u32 m0, s30, 68608
  s_add_u32 s31, s51, 239616
  buffer_load_dwordx4 v81, s[56:59], s31 offen sc1 lds
  s_lshl_b32 s30, s38, 12
  s_add_u32 m0, s30, 69632
  s_add_u32 s31, s51, 239616
  buffer_load_dwordx4 v82, s[56:59], s31 offen sc1 lds
  s_lshl_b32 s30, s38, 12
  s_add_u32 m0, s30, 70656
  s_add_u32 s31, s51, 239616
  buffer_load_dwordx4 v83, s[56:59], s31 offen sc1 lds
  s_waitcnt vmcnt(12)
  s_barrier
  s_waitcnt vmcnt(8)
  s_barrier
  v_mov_b32 v3, 148496
  s_cmp_lg_u32 s38, 0
  s_cbranch_scc1 Lsp_83
  s_mov_b32 s32, 0
Lpp_85:
  buffer_load_dword v96, v86, s[56:59], 0 offen sc1
  s_waitcnt vmcnt(0)
  v_cmp_eq_u32 vcc, s81, v96
  s_nop 3
  s_cmp_eq_u64 vcc, -1
  s_cbranch_scc1 Lppd_86
  s_add_u32 s32, s32, 1
  s_cmp_lt_u32 s32, 16384
  s_cbranch_scc1 Lpp_85
Lppd_86:
  v_mov_b32 v4, 9
  ds_write_b32 v3, v4
  s_waitcnt lgkmcnt(0)
  s_branch Lspd_84
Lsp_83:
  s_mov_b32 s32, 0
Lspl_87:
  ds_read_b32 v4, v3
  s_waitcnt lgkmcnt(0)
  v_cmp_le_u32 vcc, 9, v4
  s_nop 3
  s_cmp_eq_u64 vcc, -1
  s_cbranch_scc1 Lspd_84
  s_add_u32 s32, s32, 1
  s_cmp_lt_u32 s32, 262144
  s_cbranch_scc1 Lspl_87
Lspd_84:
  s_lshl_b32 s30, s38, 12
  s_add_u32 m0, s30, 18432
  s_add_u32 s31, s51, 18432
  buffer_load_dwordx4 v80, s[56:59], s31 offen sc1 lds
  s_lshl_b32 s30, s38, 12
  s_add_u32 m0, s30, 19456
  s_add_u32 s31, s51, 18432
  buffer_load_dwordx4 v81, s[56:59], s31 offen sc1 lds
  s_lshl_b32 s30, s38, 12
  s_add_u32 m0, s30, 20480
  s_add_u32 s31, s51, 18432
  buffer_load_dwordx4 v82, s[56:59], s31 offen sc1 lds
  s_lshl_b32 s30, s38, 12
  s_add_u32 m0, s30, 21504
  s_add_u32 s31, s51, 18432
  buffer_load_dwordx4 v83, s[56:59], s31 offen sc1 lds
  s_waitcnt vmcnt(8)
  s_barrier
  s_lshl_b32 s30, s38, 12
  s_add_u32 m0, s30, 34816
  s_add_u32 s31, s51, 92160
  buffer_load_dwordx4 v80, s[56:59], s31 offen sc1 lds
  s_lshl_b32 s30, s38, 12
  s_add_u32 m0, s30, 35840
  s_add_u32 s31, s51, 92160
  buffer_load_dwordx4 v81, s[56:59], s31 offen sc1 lds
  s_lshl_b32 s30, s38, 12
  s_add_u32 m0, s30, 36864
  s_add_u32 s31, s51, 92160
  buffer_load_dwordx4 v82, s[56:59], s31 offen sc1 lds
  s_lshl_b32 s30, s38, 12
  s_add_u32 m0, s30, 37888
  s_add_u32 s31, s51, 92160
  buffer_load_dwordx4 v83, s[56:59], s31 offen sc1 lds
  s_waitcnt vmcnt(8)
  s_barrier
  s_lshl_b32 s30, s38, 12
  s_add_u32 m0, s30, 51200
  s_add_u32 s31, s51, 147456
  buffer_load_dwordx4 v80, s[56:59], s31 offen sc1 lds
  s_lshl_b32 s30, s38, 12
  s_add_u32 m0, s30, 52224
  s_add_u32 s31, s51, 147456
  buffer_load_dwordx4 v81, s[56:59], s31 offen sc1 lds
  s_lshl_b32 s30, s38, 12
  s_add_u32 m0, s30, 53248
  s_add_u32 s31, s51, 147456
  buffer_load_dwordx4 v82, s[56:59], s31 offen sc1 lds
  s_lshl_b32 s30, s38, 12
  s_add_u32 m0, s30, 54272
  s_add_u32 s31, s51, 147456
  buffer_load_dwordx4 v83, s[56:59], s31 offen sc1 lds
  s_waitcnt vmcnt(8)
  s_barrier
  s_lshl_b32 s30, s38, 12
  s_add_u32 m0, s30, 67584
  s_add_u32 s31, s51, 221184
  buffer_load_dwordx4 v80, s[56:59], s31 offen sc1 lds
  s_lshl_b32 s30, s38, 12
  s_add_u32 m0, s30, 68608
  s_add_u32 s31, s51, 221184
  buffer_load_dwordx4 v81, s[56:59], s31 offen sc1 lds
  s_lshl_b32 s30, s38, 12
  s_add_u32 m0, s30, 69632
  s_add_u32 s31, s51, 221184
  buffer_load_dwordx4 v82, s[56:59], s31 offen sc1 lds
  s_lshl_b32 s30, s38, 12
  s_add_u32 m0, s30, 70656
  s_add_u32 s31, s51, 221184
  buffer_load_dwordx4 v83, s[56:59], s31 offen sc1 lds
  s_waitcnt vmcnt(8)
  s_barrier
  s_lshl_b32 s30, s38, 12
  s_add_u32 m0, s30, 18432
  s_lshl_b32 s31, s38, 2
  s_add_u32 s31, s31, 0
  s_mul_i32 s31, s31, 18432
  s_add_u32 s31, s31, s51
  buffer_load_dwordx4 v84, s[56:59], s31 offen sc1 lds
  s_lshl_b32 s30, s38, 12
  s_add_u32 m0, s30, 19456
  s_lshl_b32 s31, s38, 2
  s_add_u32 s31, s31, 1
  s_mul_i32 s31, s31, 18432
  s_add_u32 s31, s31, s51
  buffer_load_dwordx4 v84, s[56:59], s31 offen sc1 lds
  s_lshl_b32 s30, s38, 12
  s_add_u32 m0, s30, 20480
  s_lshl_b32 s31, s38, 2
  s_add_u32 s31, s31, 2
  s_mul_i32 s31, s31, 18432
  s_add_u32 s31, s31, s51
  buffer_load_dwordx4 v84, s[56:59], s31 offen sc1 lds
  s_lshl_b32 s30, s38, 12
  s_add_u32 m0, s30, 21504
  s_lshl_b32 s31, s38, 2
  s_add_u32 s31, s31, 3
  s_mul_i32 s31, s31, 18432
  s_add_u32 s31, s31, s51
  buffer_load_dwordx4 v84, s[56:59], s31 offen sc1 lds
  s_waitcnt vmcnt(8)
  s_barrier
  s_waitcnt vmcnt(4)
  s_barrier
  s_waitcnt vmcnt(0)
  s_barrier
  s_barrier
concat_heads__mha_block__mha_block__prompt_kernel_fin:
concat_heads__mha_block__mha_block__prompt_kernel_end:
  s_endpgm
.section .rodata,"a"
.p2align 6
.amdhsa_kernel concat_heads__mha_block__mha_block__prompt_kernel
  .amdhsa_next_free_vgpr 164
  .amdhsa_next_free_sgpr 102
  .amdhsa_accum_offset 164
  .amdhsa_group_segment_fixed_size 0
  .amdhsa_kernarg_size 72
  .amdhsa_user_sgpr_count 2
  .amdhsa_user_sgpr_kernarg_segment_ptr 1
  .amdhsa_system_sgpr_workgroup_id_x 1
  .amdhsa_float_denorm_mode_32 3
.end_amdhsa_kernel
```
